```python
import torch

def _softmax(x, axis=-1):
    return torch.softmax(x, dim=axis)
def _gelu(x):
    return torch.nn.functional.gelu(x, approximate="tanh")
def _silu(x):
    return torch.nn.functional.silu(x)
def _sigmoid(x):
    return torch.sigmoid(x)
def _layernorm(x, axis=-1, eps=1e-5):
    m = x.mean(dim=axis, keepdim=True)
    v = x.var(dim=axis, keepdim=True, unbiased=False)
    return (x - m) / torch.sqrt(v + eps)
def _scatter_add(tgt, idx, src, axis=0):
    return tgt.clone().index_add_(axis, idx, src)
def _segment_sum(src, seg, n):
    out = torch.zeros((n,) + src.shape[1:], dtype=src.dtype)
    return out.index_add_(0, seg, src)
def _pad(x, pw):
    flat = tuple(v for pair in reversed(pw) for v in pair)
    return torch.nn.functional.pad(x, flat)

kernel_name = 'gated_mix__sliding_local_dilated__dense_activation_squared_relu__prompt'

def setup_inputs():

    _w = (lambda a: (lambda t: t.to(torch.bfloat16) if t.is_floating_point() else t)(torch.as_tensor(a)))
    def _A_setup():
        B, S, D = 1, 2048, 448
        return {
            "x": _w((lambda *s: torch.randn(*s, dtype=torch.bfloat16) * 0.05)(B, S, D)),
            "wqkv": _w((lambda *s: torch.randn(*s, dtype=torch.bfloat16) * 0.8)(D, 3 * D)),
            "wo": _w((lambda *s: torch.randn(*s, dtype=torch.bfloat16) * 0.05)(D, D)),
        }
    _A_in = _A_setup()

    def _B_setup():
        B, S, D, F = 1, 2048, 448, 1792
        return {
            "x": _w((lambda *s: torch.randn(*s, dtype=torch.bfloat16) * 0.05)(B, S, D)),
            "w1": _w((lambda *s: torch.randn(*s, dtype=torch.bfloat16) * 0.1)(D, F)),
            "b1": _w((lambda *s: torch.randn(*s, dtype=torch.bfloat16) * 0.1)(F)),
            "w2": _w((lambda *s: torch.randn(*s, dtype=torch.bfloat16) * 0.1)(F, D)),
            "b2": _w((lambda *s: torch.randn(*s, dtype=torch.bfloat16) * 0.1)(D)),
        }
    _B_in = _B_setup()

    return {
        "A_x": _A_in["x"],
        "A_wqkv": _A_in["wqkv"],
        "A_wo": _A_in["wo"],
        "B_x": _B_in["x"],
        "B_w1": _B_in["w1"],
        "B_b1": _B_in["b1"],
        "B_w2": _B_in["w2"],
        "B_b2": _B_in["b2"],
        "gate_w": _w((lambda *s: torch.randn(*s, dtype=torch.bfloat16) * 0.05)(448) * 16.0),
    }

def reference(A_x, A_wqkv, A_wo, B_x, B_w1, B_b1, B_w2, B_b2, gate_w):
    def _A_ref(x, wqkv, wo):
        B, S, D = x.shape
        H = 16; Dh = D // H
        W, dil = 8, 2
        qkv = (lambda x, *d: x.permute(*d))((x @ wqkv).reshape(B, S, 3, H, Dh), 2, 0, 3, 1, 4)
        q, k, v = qkv[0], qkv[1], qkv[2]
        scale = Dh ** -0.5
        pos = torch.arange(S)
        off = torch.arange(W) * dil
        idx = pos[:, None] - off[None, :]
        mask = idx >= 0
        idx_c = torch.where(mask, idx, 0).reshape(-1)
        kg = k[:, :, idx_c, :].reshape(B, H, S, W, Dh)
        vg = v[:, :, idx_c, :].reshape(B, H, S, W, Dh)
        logits = torch.einsum("bhsd,bhswd->bhsw", q, kg) * scale
        logits = torch.where(mask[None, None, :, :], logits, -1e9)
        attn = _softmax(logits, axis=-1)
        o = torch.einsum("bhsw,bhswd->bhsd", attn, vg)
        return (lambda x, *d: x.permute(*d))(o, 0, 2, 1, 3).reshape(B, S, D) @ wo

    def _B_ref(x, w1, b1, w2, b2):
        h = torch.einsum("bsd,df->bsf", x, w1) + b1
        zero = torch.zeros_like(h)
        r = torch.where(h > zero, h, zero)
        h = r * r
        out = torch.einsum("bsf,fd->bsd", h, w2) + b2
        return out

    x = A_x
    g = _sigmoid((x * gate_w).sum(-1, keepdims=True))
    a = _A_ref(x, A_wqkv, A_wo)
    b = _B_ref(x, B_w1, B_b1, B_w2, B_b2)
    return g * a + (1 - g) * b
```

```asm
; @launch grid=(256,1,1) block=(512,1,1) lds=162816
.amdgcn_target "amdgcn-amd-amdhsa--gfx950"
.text
.globl gated_mix__sliding_local_dilated__dense_activation_squared_relu__prompt_kernel
.p2align 8
.type gated_mix__sliding_local_dilated__dense_activation_squared_relu__prompt_kernel,@function
gated_mix__sliding_local_dilated__dense_activation_squared_relu__prompt_kernel:
  s_cmp_ge_u32 s2, 256
  s_cbranch_scc1 L_exit
  s_load_dwordx16 s[8:23], s[0:1], 0
  s_load_dwordx8 s[24:31], s[0:1], 64
  v_lshrrev_b32 v1, 6, v0
  v_and_b32 v0, 63, v0
  v_readfirstlane_b32 s52, v1
  s_and_b32 s53, s2, 7
  s_lshr_b32 s54, s2, 3
  s_and_b32 s55, s53, 1
  s_lshl_b32 s55, s55, 3
  s_and_b32 s60, s54, 7
  s_add_u32 s55, s55, s60
  s_lshr_b32 s56, s54, 3
  s_lshl_b32 s56, s56, 2
  s_lshr_b32 s60, s53, 1
  s_xor_b32 s60, s60, 3
  s_add_u32 s56, s56, s60
  s_and_b32 s68, s52, 3
  s_cmp_ge_u32 s52, 4
  s_cbranch_scc1 L_p2
  s_waitcnt lgkmcnt(0)
  s_mov_b32 s65, 13407744
  s_load_dword s67, s[30:31], s65
  v_mov_b32 v15, 0
  v_mov_b32 v12, 161792
  s_mov_b32 s32, s30
  s_and_b32 s33, s31, 0xffff
  s_mov_b32 s34, 13538944
  s_mov_b32 s35, 0x00020000
  v_lshlrev_b32 v14, 4, v0
  s_mov_b32 s48, s30
  s_and_b32 s49, s31, 0xffff
  s_mov_b32 s50, 0
  s_mov_b32 s51, 0x00020000
  s_mov_b32 s69, 0
  s_mov_b32 s74, 0
  s_mov_b32 s75, 0
  v_mov_b32 v242, 0
  v_mov_b32 v243, 0
  s_cmp_lg_u32 s68, 0
  s_cbranch_scc1 Lnorp_1
  v_lshrrev_b32 v1, 4, v0
  v_bfe_u32 v2, v0, 2, 2
  v_and_b32 v3, 3, v0
  s_cmp_lt_u32 s2, 224
  s_mov_b32 s48, s32
  s_mov_b32 s49, s33
  s_cselect_b32 s50, s34, 0
  s_mov_b32 s51, 0x00020000
  s_mov_b32 s40, s10
  s_and_b32 s41, s11, 0xffff
  s_mov_b32 s42, 1204224
  s_mov_b32 s43, 0x00020000
  s_min_u32 s65, s2, 223
  s_mul_i32 s60, s65, 4682
  s_lshr_b32 s60, s60, 16
  s_mul_i32 s61, s60, 14
  s_sub_u32 s61, s65, s61
  v_lshrrev_b32 v4, 2, v0
  v_mul_u32_u24 v5, 2688, v4
  v_lshl_add_u32 v5, v3, 4, v5
  s_mul_i32 s62, s61, 86016
  s_mul_i32 s63, s60, 56
  s_add_u32 s62, s62, s63
  s_add_u32 s63, s62, 43008
  buffer_load_dwordx4 v[64:67], v5, s[40:43], s62 offen offset:0
  buffer_load_dwordx4 v[68:71], v5, s[40:43], s63 offen offset:0
  buffer_load_dwordx4 v[72:75], v5, s[40:43], s62 offen offset:896
  buffer_load_dwordx4 v[76:79], v5, s[40:43], s63 offen offset:896
  buffer_load_dwordx4 v[80:83], v5, s[40:43], s62 offen offset:1792
  buffer_load_dwordx4 v[84:87], v5, s[40:43], s63 offen offset:1792
  s_lshl_b32 s64, s61, 6
  v_lshl_add_u32 v5, v4, 1, s64
  global_load_ushort v240, v5, s[24:25]
  global_load_ushort v241, v5, s[24:25] offset:32
  v_mul_u32_u24 v6, 192, v4
  v_lshl_add_u32 v6, v3, 4, v6
  v_add_u32 v6, 147456, v6
  v_and_b32 v4, 1, v1
  v_lshrrev_b32 v5, 1, v1
  v_lshl_add_u32 v4, v4, 1, v5
  v_lshl_add_u32 v7, v4, 3, v2
  v_mul_u32_u24 v7, 192, v7
  v_lshl_add_u32 v7, v3, 3, v7
  v_add_u32 v7, 147456, v7
  s_lshl_b32 s60, s60, 7
  s_lshl_b32 s61, s61, 2
  s_add_u32 s60, s60, s61
  s_add_u32 s69, s60, 13402112
  s_mul_i32 s74, s65, 6144
  s_add_u32 s74, s74, 11501568
  s_add_u32 s75, s74, 4096
  v_mov_b32 v242, v6
  v_mov_b32 v243, v7
Lnorp_1:
  s_cmp_lg_u32 s68, 3
  s_cbranch_scc1 Lnot3_2
  s_mov_b32 s44, s18
  s_and_b32 s45, s19, 0xffff
  s_mov_b32 s46, 3584
  s_mov_b32 s47, 0x00020000
  v_lshlrev_b32 v4, 2, v0
  s_lshl_b32 s63, s56, 8
  buffer_load_dword v5, v4, s[44:47], s63 offen
  v_add_u32 v6, 161792, v4
  ds_write_b32 v6, v15
  s_waitcnt lgkmcnt(0)
  s_add_u32 s67, s67, 1
  s_barrier
  v_lshlrev_b32 v6, 3, v0
  v_add_u32 v6, 162304, v6
  s_waitcnt vmcnt(0)
  v_lshlrev_b32 v2, 16, v5
  v_and_b32 v3, 0xffff0000, v5
  ds_write_b64 v6, v[2:3]
  v_mov_b32 v2, 1
  s_waitcnt lgkmcnt(0)
  s_mov_b64 exec, 1
  ds_write_b32 v12, v2 offset:36
  s_mov_b64 exec, -1
  s_branch Lbj_3
Lnot3_2:
  s_waitcnt lgkmcnt(0)
  s_add_u32 s67, s67, 1
  s_barrier
Lbj_3:
  s_lshl_b32 s63, s68, 2
  s_add_u32 s63, s63, 161792
  v_lshlrev_b32 v13, 2, v0
  v_add_u32 v13, 162048, v13
  v_writelane_b32 v13, s63, 0
  v_and_b32 v1, 31, v0
  v_lshrrev_b32 v2, 5, v0
  v_bfe_u32 v3, v0, 1, 3
  v_xor_b32 v3, v3, v2
  v_lshlrev_b32 v3, 4, v3
  v_lshl_add_u32 v3, v1, 7, v3
  s_lshl_b32 s63, s68, 12
  v_add_u32 v8, s63, v3
  v_xor_b32 v9, 32, v8
  v_xor_b32 v10, 64, v8
  v_xor_b32 v11, 96, v8
  v_lshlrev_b32 v23, 4, v2
  v_add_u32 v23, 162304, v23
  v_and_b32 v3, 15, v0
  v_bfe_u32 v4, v0, 4, 1
  v_lshlrev_b32 v3, 4, v3
  v_lshl_add_u32 v3, v4, 10, v3
  v_lshl_add_u32 v22, v2, 8, v3
  v_bfe_u32 v3, v0, 2, 2
  v_lshl_add_u32 v5, v2, 3, v3
  v_lshlrev_b32 v5, 7, v5
  v_lshl_add_u32 v5, v4, 5, v5
  v_and_b32 v6, 3, v0
  v_lshl_add_u32 v5, v6, 3, v5
  v_lshrrev_b32 v6, 1, v3
  v_lshl_add_u32 v16, v6, 6, v5
  v_xor_b32 v17, 64, v16
  v_add_u32 v18, 65536, v16
  v_add_u32 v19, 65536, v17
  v_add_u32 v20, 122880, v16
  v_add_u32 v21, 122880, v17
  v_and_b32 v1, 15, v0
  v_lshl_add_u32 v2, v4, 1, v2
  v_lshrrev_b32 v3, 2, v1
  v_lshlrev_b32 v4, 1, v3
  v_mov_b32 v5, 180
  v_lshrrev_b32 v4, v4, v5
  v_and_b32 v4, 3, v4
  v_xor_b32 v4, v4, v2
  v_lshl_add_u32 v4, v1, 2, v4
  v_lshlrev_b32 v4, 4, v4
  v_add_u32 v4, 6144, v4
  s_lshl_b32 s63, s68, 10
  s_add_u32 s63, s63, 2048
  v_add_u32 v5, s63, v14
  s_cmp_lt_u32 s68, 2
  s_cselect_b64 vcc, -1, 0
  v_cndmask_b32 v30, v4, v5, vcc
  v_cndmask_b32 v31, v5, v4, vcc
  s_lshr_b32 s63, s68, 1
  s_lshl_b32 s57, s55, 1
  s_add_u32 s57, s57, s63
  s_lshl_b32 s63, s57, 4
  s_add_u32 s63, s63, s56
  s_lshl_b32 s63, s63, 1
  s_and_b32 s64, s68, 1
  s_add_u32 s63, s63, s64
  s_lshl_b32 s65, s63, 7
  s_mov_b32 s76, s65
  s_cmp_ge_u32 s56, 14
  s_cbranch_scc1 L_p1_noa
  s_mul_i32 s63, s57, 72
  s_lshl_b32 s64, s56, 1
  s_add_u32 s63, s63, s64
  s_lshl_b32 s63, s63, 12
  s_and_b32 s64, s68, 1
  s_lshl_b32 s64, s64, 11
  s_add_u32 s72, s63, s64
  s_add_u32 s6, s76, 13008896
  ds_read_b32 v24, v12 offset:36
  s_waitcnt lgkmcnt(0)
  v_cmp_gt_u32 vcc, 1, v24
  s_cbranch_vccnz Lspin_5
Lok_4:
  ds_read_b128 v[144:147], v23 offset:0
  ds_read_b128 v[148:151], v23 offset:32
  ds_read_b128 v[152:155], v23 offset:64
  ds_read_b128 v[156:159], v23 offset:96
  ds_read_b128 v[160:163], v23 offset:128
  ds_read_b128 v[164:167], v23 offset:160
  ds_read_b128 v[168:171], v23 offset:192
  ds_read_b128 v[172:175], v23 offset:224
  ds_read_b128 v[176:179], v23 offset:256
  ds_read_b128 v[180:183], v23 offset:288
  ds_read_b128 v[184:187], v23 offset:320
  ds_read_b128 v[188:191], v23 offset:352
  ds_read_b128 v[192:195], v23 offset:384
  ds_read_b128 v[196:199], v23 offset:416
  ds_read_b128 v[200:203], v23 offset:448
  ds_read_b128 v[204:207], v23 offset:480
  s_waitcnt lgkmcnt(0)
  s_mov_b32 s7, 1
  v_mov_b32 v28, s67
  ds_read_b128 v[24:27], v12 offset:16
  s_waitcnt lgkmcnt(0)
  v_min3_u32 v24, v24, v25, v26
  v_min_u32 v24, v24, v27
  v_cmp_gt_u32 vcc, 6, v24
  s_cbranch_vccnz Lspin_7
Lok_6:
  ds_read_b128 v[32:35], v8 offset:0
  ds_read_b128 v[88:91], v9 offset:0
  ds_read_b128 v[36:39], v10 offset:0
  ds_read_b128 v[92:95], v11 offset:0
  ds_read_b128 v[24:27], v12 offset:16
  s_waitcnt lgkmcnt(0)
  v_min3_u32 v24, v24, v25, v26
  v_min_u32 v24, v24, v27
  ds_read_b64_tr_b16 v[208:209], v18 offset:0
  ds_read_b64_tr_b16 v[210:211], v18 offset:512
  ds_read_b64_tr_b16 v[212:213], v19 offset:0
  ds_read_b64_tr_b16 v[214:215], v19 offset:512
  ds_read_b64_tr_b16 v[216:217], v18 offset:2048
  ds_read_b64_tr_b16 v[218:219], v18 offset:2560
  ds_read_b64_tr_b16 v[220:221], v19 offset:2048
  ds_read_b64_tr_b16 v[222:223], v19 offset:2560
  ds_read_b64_tr_b16 v[224:225], v18 offset:4096
  ds_read_b64_tr_b16 v[226:227], v18 offset:4608
  v_cmp_gt_u32 vcc, 12, v24
  ds_read_b64_tr_b16 v[228:229], v19 offset:4096
  ds_read_b64_tr_b16 v[230:231], v19 offset:4608
  s_waitcnt lgkmcnt(10)
  v_mfma_f32_32x32x16_bf16 v[144:159], v[208:211], v[32:35], v[144:159]
  v_mov_b32 v29, 2
  ds_write_b32 v13, v29
  s_cbranch_vccnz Lspin_9
Lok_8:
  ds_read_b128 v[40:43], v8 offset:16384
  ds_read_b128 v[96:99], v9 offset:16384
  ds_read_b64_tr_b16 v[232:233], v18 offset:6144
  ds_read_b64_tr_b16 v[234:235], v18 offset:6656
  s_waitcnt lgkmcnt(13)
  v_mfma_f32_32x32x16_bf16 v[160:175], v[212:215], v[32:35], v[160:175]
  ds_read_b128 v[44:47], v10 offset:16384
  ds_read_b128 v[100:103], v11 offset:16384
  ds_read_b64_tr_b16 v[236:237], v19 offset:6144
  ds_read_b64_tr_b16 v[238:239], v19 offset:6656
  s_waitcnt lgkmcnt(15)
  v_mfma_f32_32x32x16_bf16 v[144:159], v[216:219], v[88:91], v[144:159]
  ds_read_b128 v[24:27], v12 offset:16
  ds_read_b64_tr_b16 v[208:209], v18 offset:8192
  ds_read_b64_tr_b16 v[210:211], v18 offset:8704
  s_waitcnt lgkmcnt(15)
  v_mfma_f32_32x32x16_bf16 v[160:175], v[220:223], v[88:91], v[160:175]
  ds_read_b64_tr_b16 v[212:213], v19 offset:8192
  ds_read_b64_tr_b16 v[214:215], v19 offset:8704
  s_waitcnt lgkmcnt(15)
  v_mfma_f32_32x32x16_bf16 v[144:159], v[224:227], v[36:39], v[144:159]
  s_cmp_lg_u32 s68, 0
  s_cbranch_scc1 Lsk_34
  v_mov_b32 v6, v242
  v_mov_b32 v7, v243
  v_and_b32 v3, 3, v0
  s_waitcnt vmcnt(0)
  v_cmp_eq_u32 vcc, 3, v3
  s_nop 1
  v_cndmask_b32 v66, v66, v240, vcc
  v_cndmask_b32 v67, v67, v15, vcc
  ds_write_b128 v6, v[64:67] offset:0
  v_cndmask_b32 v70, v70, v241, vcc
  v_cndmask_b32 v71, v71, v15, vcc
  ds_write_b128 v6, v[68:71] offset:3072
  v_cndmask_b32 v74, v74, v15, vcc
  v_cndmask_b32 v75, v75, v15, vcc
  ds_write_b128 v6, v[72:75] offset:64
  v_cndmask_b32 v78, v78, v15, vcc
  v_cndmask_b32 v79, v79, v15, vcc
  ds_write_b128 v6, v[76:79] offset:3136
  v_cndmask_b32 v82, v82, v15, vcc
  v_cndmask_b32 v83, v83, v15, vcc
  ds_write_b128 v6, v[80:83] offset:128
  v_cndmask_b32 v86, v86, v15, vcc
  v_cndmask_b32 v87, v87, v15, vcc
  ds_write_b128 v6, v[84:87] offset:3200
  ds_read_b64_tr_b16 v[120:121], v7 offset:0
  ds_read_b64_tr_b16 v[122:123], v7 offset:768
  ds_read_b64_tr_b16 v[124:125], v7 offset:32
  ds_read_b64_tr_b16 v[126:127], v7 offset:800
  ds_read_b64_tr_b16 v[128:129], v7 offset:64
  ds_read_b64_tr_b16 v[130:131], v7 offset:832
  ds_read_b64_tr_b16 v[132:133], v7 offset:96
  ds_read_b64_tr_b16 v[134:135], v7 offset:864
  ds_read_b64_tr_b16 v[136:137], v7 offset:128
  ds_read_b64_tr_b16 v[138:139], v7 offset:896
  ds_read_b64_tr_b16 v[140:141], v7 offset:160
  ds_read_b64_tr_b16 v[142:143], v7 offset:928
  s_waitcnt lgkmcnt(10)
  buffer_store_dwordx4 v[120:123], v14, s[48:51], s74 offen offset:0 sc1
  s_waitcnt lgkmcnt(8)
  buffer_store_dwordx4 v[124:127], v14, s[48:51], s74 offen offset:1024 sc1
  s_waitcnt lgkmcnt(6)
  buffer_store_dwordx4 v[128:131], v14, s[48:51], s74 offen offset:2048 sc1
  s_waitcnt lgkmcnt(4)
  buffer_store_dwordx4 v[132:135], v14, s[48:51], s74 offen offset:3072 sc1
  s_waitcnt lgkmcnt(2)
  buffer_store_dwordx4 v[136:139], v14, s[48:51], s75 offen offset:0 sc1
  s_waitcnt lgkmcnt(0)
  buffer_store_dwordx4 v[140:143], v14, s[48:51], s75 offen offset:1024 sc1
  s_mov_b32 s7, 0
Lsk_34:
  s_sub_u32 s60, s68, 1
  s_cmp_ge_u32 s60, 2
  s_cbranch_scc1 Lsk_35
  v_lshrrev_b32 v1, 4, v0
  v_bfe_u32 v2, v0, 2, 2
  v_and_b32 v3, 3, v0
  s_lshl_b32 s60, s2, 1
  s_add_u32 s60, s60, s68
  s_sub_u32 s60, s60, 1
  s_cmp_lt_u32 s60, 504
  s_mov_b32 s48, s32
  s_mov_b32 s49, s33
  s_cselect_b32 s50, s34, 0
  s_mov_b32 s51, 0x00020000
  s_min_u32 s60, s60, 503
  s_mul_i32 s61, s60, 911
  s_lshr_b32 s61, s61, 16
  s_mul_i32 s62, s61, 72
  s_sub_u32 s62, s60, s62
  s_cmp_lt_u32 s62, 56
  s_cselect_b32 s40, s20, s12
  s_cselect_b32 s41, s21, s13
  s_mov_b32 s63, 1605632
  s_mov_b32 s64, 401408
  s_cselect_b32 s42, s63, s64
  s_mov_b32 s43, 0x00020000
  s_cselect_b64 vcc, 0, -1
  s_cmp_ge_u32 s62, 28
  s_cselect_b32 s64, 28, 0
  s_cselect_b32 s65, 64, 0
  s_sub_u32 s64, s62, s64
  s_lshr_b32 s63, s64, 1
  s_lshl_b32 s63, s63, 7
  s_add_u32 s63, s63, s65
  s_and_b32 s64, s64, 1
  s_lshl_b32 s64, s64, 5
  s_add_u32 s63, s63, s64
  s_sub_u32 s64, s62, 56
  s_mul_i32 s64, s64, 28
  s_cmp_lt_u32 s62, 56
  s_cselect_b32 s63, s63, s64
  s_and_b32 s41, s41, 0xffff
  s_mul_i32 s63, s63, 896
  s_lshl_b32 s64, s61, 7
  s_add_u32 s63, s63, s64
  v_and_b32 v4, 1, v1
  v_lshrrev_b32 v5, 1, v1
  v_lshlrev_b32 v4, 2, v4
  v_lshl_add_u32 v4, v5, 4, v4
  v_lshlrev_b32 v5, 2, v1
  v_cndmask_b32 v6, v4, v5, vcc
  v_mov_b32 v4, 1024
  v_mov_b32 v5, 2048
  v_cndmask_b32 v7, v4, v5, vcc
  v_lshrrev_b32 v4, 3, v0
  v_mul_u32_u24 v4, 896, v4
  v_and_b32 v5, 7, v0
  v_lshl_add_u32 v4, v5, 4, v4
  s_mov_b32 vcc_lo, 0
  v_mov_b32 v5, 0x40000000
  s_nop 1
  v_cndmask_b32 v5, v4, v5, vcc
  s_lshl_b32 s64, s68, 12
  s_add_u32 m0, s64, 149504
  s_nop 0
  buffer_load_dwordx4 v4, s[40:43], s63 offen offset:0 lds
  s_add_u32 s63, s63, 6144
  buffer_load_dwordx4 v4, s[40:43], s63 offen offset:1024 lds
  s_add_u32 s63, s63, 6144
  buffer_load_dwordx4 v4, s[40:43], s63 offen offset:2048 lds
  s_add_u32 s63, s63, 6144
  buffer_load_dwordx4 v5, s[40:43], s63 offen offset:3072 lds
  v_add_u32 v6, v6, v2
  v_lshlrev_b32 v6, 7, v6
  v_lshl_add_u32 v6, v3, 3, v6
  v_add_u32 v6, m0, v6
  v_add_u32 v7, v6, v7
  s_mul_i32 s63, s62, 9363
  s_lshr_b32 s63, s63, 16
  s_mul_i32 s64, s63, 7
  s_sub_u32 s64, s62, s64
  s_lshr_b32 s65, s63, 2
  s_mul_i32 s65, s65, 7
  s_add_u32 s64, s64, s65
  s_and_b32 s63, s63, 3
  s_sub_u32 s65, s62, 56
  s_lshr_b32 s70, s65, 2
  s_and_b32 s65, s65, 3
  s_add_u32 s65, s65, 14
  s_cmp_lt_u32 s62, 56
  s_cselect_b32 s63, s63, s70
  s_cselect_b32 s64, s64, s65
  s_lshl_b32 s61, s61, 2
  s_add_u32 s61, s61, s63
  s_lshl_b32 s61, s61, 7
  s_lshl_b32 s64, s64, 2
  s_add_u32 s61, s61, s64
  s_add_u32 s69, s61, 13404160
  s_lshl_b32 s74, s60, 12
  s_add_u32 s74, s74, 9437184
Lsk_35:
  ds_read_b64_tr_b16 v[216:217], v18 offset:10240
  ds_read_b64_tr_b16 v[218:219], v18 offset:10752
  s_waitcnt lgkmcnt(15)
  v_mfma_f32_32x32x16_bf16 v[160:175], v[228:231], v[36:39], v[160:175]
  s_waitcnt lgkmcnt(6)
  v_min3_u32 v24, v24, v25, v26
  ds_read_b64_tr_b16 v[220:221], v19 offset:10240
  ds_read_b64_tr_b16 v[222:223], v19 offset:10752
  v_mfma_f32_32x32x16_bf16 v[144:159], v[232:235], v[92:95], v[144:159]
  v_min_u32 v24, v24, v27
  ds_read_b64_tr_b16 v[224:225], v18 offset:12288
  ds_read_b64_tr_b16 v[226:227], v18 offset:12800
  v_mfma_f32_32x32x16_bf16 v[160:175], v[236:239], v[92:95], v[160:175]
  v_cmp_gt_u32 vcc, 22, v24
  ds_read_b64_tr_b16 v[228:229], v19 offset:12288
  ds_read_b64_tr_b16 v[230:231], v19 offset:12800
  s_waitcnt lgkmcnt(10)
  v_mfma_f32_32x32x16_bf16 v[144:159], v[208:211], v[40:43], v[144:159]
  v_mov_b32 v29, 3
  ds_write_b32 v13, v29
  s_cbranch_vccnz Lspin_11
Lok_10:
  ds_read_b128 v[48:51], v8 offset:32768
  ds_read_b128 v[104:107], v9 offset:32768
  s_getreg_b32 s3, hwreg(HW_REG_IB_STS)
  s_and_b32 s3, s3, 0x00c0000f
  s_or_b32 s3, s3, s7
  s_cbranch_scc1 Ltf_36
  s_mov_b64 exec, 1
  buffer_store_dword v28, v15, s[48:51], s69 offen sc1
  s_mov_b64 exec, -1
  s_mov_b32 s7, 1
Ltf_36:
  ds_read_b64_tr_b16 v[232:233], v18 offset:14336
  ds_read_b64_tr_b16 v[234:235], v18 offset:14848
  s_waitcnt lgkmcnt(13)
  v_mfma_f32_32x32x16_bf16 v[160:175], v[212:215], v[40:43], v[160:175]
  ds_read_b128 v[52:55], v10 offset:32768
  ds_read_b128 v[108:111], v11 offset:32768
  ds_read_b64_tr_b16 v[236:237], v19 offset:14336
  ds_read_b64_tr_b16 v[238:239], v19 offset:14848
  s_waitcnt lgkmcnt(15)
  v_mfma_f32_32x32x16_bf16 v[144:159], v[216:219], v[96:99], v[144:159]
  ds_read_b128 v[24:27], v12 offset:16
  ds_read_b64_tr_b16 v[208:209], v18 offset:16384
  ds_read_b64_tr_b16 v[210:211], v18 offset:16896
  s_waitcnt lgkmcnt(15)
  v_mfma_f32_32x32x16_bf16 v[160:175], v[220:223], v[96:99], v[160:175]
  ds_read_b64_tr_b16 v[212:213], v19 offset:16384
  ds_read_b64_tr_b16 v[214:215], v19 offset:16896
  s_waitcnt lgkmcnt(15)
  v_mfma_f32_32x32x16_bf16 v[144:159], v[224:227], v[44:47], v[144:159]
  s_getreg_b32 s3, hwreg(HW_REG_IB_STS)
  s_and_b32 s3, s3, 0x00c0000f
  s_or_b32 s3, s3, s7
  s_cbranch_scc1 Ltf_37
  s_mov_b64 exec, 1
  buffer_store_dword v28, v15, s[48:51], s69 offen sc1
  s_mov_b64 exec, -1
  s_mov_b32 s7, 1
Ltf_37:
  ds_read_b64_tr_b16 v[216:217], v18 offset:18432
  ds_read_b64_tr_b16 v[218:219], v18 offset:18944
  s_waitcnt lgkmcnt(15)
  v_mfma_f32_32x32x16_bf16 v[160:175], v[228:231], v[44:47], v[160:175]
  s_waitcnt lgkmcnt(6)
  v_min3_u32 v24, v24, v25, v26
  ds_read_b64_tr_b16 v[220:221], v19 offset:18432
  ds_read_b64_tr_b16 v[222:223], v19 offset:18944
  v_mfma_f32_32x32x16_bf16 v[144:159], v[232:235], v[100:103], v[144:159]
  v_min_u32 v24, v24, v27
  ds_read_b64_tr_b16 v[224:225], v18 offset:20480
  ds_read_b64_tr_b16 v[226:227], v18 offset:20992
  v_mfma_f32_32x32x16_bf16 v[160:175], v[236:239], v[100:103], v[160:175]
  v_cmp_gt_u32 vcc, 28, v24
  ds_read_b64_tr_b16 v[228:229], v19 offset:20480
  ds_read_b64_tr_b16 v[230:231], v19 offset:20992
  s_waitcnt lgkmcnt(10)
  v_mfma_f32_32x32x16_bf16 v[144:159], v[208:211], v[48:51], v[144:159]
  v_mov_b32 v29, 4
  ds_write_b32 v13, v29
  s_cbranch_vccnz Lspin_13
Lok_12:
  ds_read_b128 v[56:59], v8 offset:49152
  ds_read_b128 v[112:115], v9 offset:49152
  s_getreg_b32 s3, hwreg(HW_REG_IB_STS)
  s_and_b32 s3, s3, 0x00c0000f
  s_or_b32 s3, s3, s7
  s_cbranch_scc1 Ltf_38
  s_mov_b64 exec, 1
  buffer_store_dword v28, v15, s[48:51], s69 offen sc1
  s_mov_b64 exec, -1
  s_mov_b32 s7, 1
Ltf_38:
  ds_read_b64_tr_b16 v[232:233], v18 offset:22528
  ds_read_b64_tr_b16 v[234:235], v18 offset:23040
  s_waitcnt lgkmcnt(13)
  v_mfma_f32_32x32x16_bf16 v[160:175], v[212:215], v[48:51], v[160:175]
  ds_read_b128 v[60:63], v10 offset:49152
  ds_read_b128 v[116:119], v11 offset:49152
  ds_read_b64_tr_b16 v[236:237], v19 offset:22528
  ds_read_b64_tr_b16 v[238:239], v19 offset:23040
  s_waitcnt lgkmcnt(15)
  v_mfma_f32_32x32x16_bf16 v[144:159], v[216:219], v[104:107], v[144:159]
  ds_read_b128 v[24:27], v12 offset:16
  ds_read_b64_tr_b16 v[208:209], v18 offset:24576
  ds_read_b64_tr_b16 v[210:211], v18 offset:25088
  s_waitcnt lgkmcnt(15)
  v_mfma_f32_32x32x16_bf16 v[160:175], v[220:223], v[104:107], v[160:175]
  ds_read_b64_tr_b16 v[212:213], v19 offset:24576
  ds_read_b64_tr_b16 v[214:215], v19 offset:25088
  s_waitcnt lgkmcnt(15)
  v_mfma_f32_32x32x16_bf16 v[144:159], v[224:227], v[52:55], v[144:159]
  s_getreg_b32 s3, hwreg(HW_REG_IB_STS)
  s_and_b32 s3, s3, 0x00c0000f
  s_or_b32 s3, s3, s7
  s_cbranch_scc1 Ltf_39
  s_mov_b64 exec, 1
  buffer_store_dword v28, v15, s[48:51], s69 offen sc1
  s_mov_b64 exec, -1
  s_mov_b32 s7, 1
Ltf_39:
  ds_read_b64_tr_b16 v[216:217], v18 offset:26624
  ds_read_b64_tr_b16 v[218:219], v18 offset:27136
  s_waitcnt lgkmcnt(15)
  v_mfma_f32_32x32x16_bf16 v[160:175], v[228:231], v[52:55], v[160:175]
  s_waitcnt lgkmcnt(6)
  v_min3_u32 v24, v24, v25, v26
  ds_read_b64_tr_b16 v[220:221], v19 offset:26624
  ds_read_b64_tr_b16 v[222:223], v19 offset:27136
  v_mfma_f32_32x32x16_bf16 v[144:159], v[232:235], v[108:111], v[144:159]
  v_min_u32 v24, v24, v27
  ds_read_b64_tr_b16 v[224:225], v18 offset:28672
  ds_read_b64_tr_b16 v[226:227], v18 offset:29184
  v_mfma_f32_32x32x16_bf16 v[160:175], v[236:239], v[108:111], v[160:175]
  v_cmp_gt_u32 vcc, 34, v24
  ds_read_b64_tr_b16 v[228:229], v19 offset:28672
  ds_read_b64_tr_b16 v[230:231], v19 offset:29184
  s_waitcnt lgkmcnt(10)
  v_mfma_f32_32x32x16_bf16 v[144:159], v[208:211], v[56:59], v[144:159]
  v_mov_b32 v29, 5
  ds_write_b32 v13, v29
  s_cbranch_vccnz Lspin_15
Lok_14:
  ds_read_b128 v[64:67], v8 offset:0
  ds_read_b128 v[120:123], v9 offset:0
  s_getreg_b32 s3, hwreg(HW_REG_IB_STS)
  s_and_b32 s3, s3, 0x00c0000f
  s_or_b32 s3, s3, s7
  s_cbranch_scc1 Ltf_40
  s_mov_b64 exec, 1
  buffer_store_dword v28, v15, s[48:51], s69 offen sc1
  s_mov_b64 exec, -1
  s_mov_b32 s7, 1
Ltf_40:
  ds_read_b64_tr_b16 v[232:233], v18 offset:30720
  ds_read_b64_tr_b16 v[234:235], v18 offset:31232
  s_waitcnt lgkmcnt(13)
  v_mfma_f32_32x32x16_bf16 v[160:175], v[212:215], v[56:59], v[160:175]
  ds_read_b128 v[68:71], v10 offset:0
  ds_read_b128 v[124:127], v11 offset:0
  ds_read_b64_tr_b16 v[236:237], v19 offset:30720
  ds_read_b64_tr_b16 v[238:239], v19 offset:31232
  s_waitcnt lgkmcnt(15)
  v_mfma_f32_32x32x16_bf16 v[144:159], v[216:219], v[112:115], v[144:159]
  ds_read_b128 v[24:27], v12 offset:16
  ds_read_b64_tr_b16 v[208:209], v18 offset:32768
  ds_read_b64_tr_b16 v[210:211], v18 offset:33280
  s_waitcnt lgkmcnt(15)
  v_mfma_f32_32x32x16_bf16 v[160:175], v[220:223], v[112:115], v[160:175]
  ds_read_b64_tr_b16 v[212:213], v19 offset:32768
  ds_read_b64_tr_b16 v[214:215], v19 offset:33280
  s_waitcnt lgkmcnt(15)
  v_mfma_f32_32x32x16_bf16 v[144:159], v[224:227], v[60:63], v[144:159]
  s_sub_u32 s60, s68, 1
  s_cmp_ge_u32 s60, 2
  s_cbranch_scc1 Lsk_41
  s_waitcnt vmcnt(0)
  ds_read_b64_tr_b16 v[240:241], v6 offset:0
  ds_read_b64_tr_b16 v[242:243], v7 offset:0
  ds_read_b64_tr_b16 v[244:245], v6 offset:32
  ds_read_b64_tr_b16 v[246:247], v7 offset:32
  ds_read_b64_tr_b16 v[248:249], v6 offset:64
  ds_read_b64_tr_b16 v[250:251], v7 offset:64
  ds_read_b64_tr_b16 v[252:253], v6 offset:96
  ds_read_b64_tr_b16 v[254:255], v7 offset:96
  s_waitcnt lgkmcnt(6)
  buffer_store_dwordx4 v[240:243], v14, s[48:51], s74 offen offset:0 sc1
  s_waitcnt lgkmcnt(4)
  buffer_store_dwordx4 v[244:247], v14, s[48:51], s74 offen offset:1024 sc1
  s_waitcnt lgkmcnt(2)
  buffer_store_dwordx4 v[248:251], v14, s[48:51], s74 offen offset:2048 sc1
  s_waitcnt lgkmcnt(0)
  buffer_store_dwordx4 v[252:255], v14, s[48:51], s74 offen offset:3072 sc1
  s_mov_b32 s7, 0
Lsk_41:
  s_getreg_b32 s3, hwreg(HW_REG_IB_STS)
  s_and_b32 s3, s3, 0x00c0000f
  s_or_b32 s3, s3, s7
  s_cbranch_scc1 Ltf_42
  s_mov_b64 exec, 1
  buffer_store_dword v28, v15, s[48:51], s69 offen sc1
  s_mov_b64 exec, -1
  s_mov_b32 s7, 1
Ltf_42:
  ds_read_b64_tr_b16 v[216:217], v18 offset:34816
  ds_read_b64_tr_b16 v[218:219], v18 offset:35328
  s_waitcnt lgkmcnt(15)
  v_mfma_f32_32x32x16_bf16 v[160:175], v[228:231], v[60:63], v[160:175]
  s_waitcnt lgkmcnt(6)
  v_min3_u32 v24, v24, v25, v26
  ds_read_b64_tr_b16 v[220:221], v19 offset:34816
  ds_read_b64_tr_b16 v[222:223], v19 offset:35328
  v_mfma_f32_32x32x16_bf16 v[144:159], v[232:235], v[116:119], v[144:159]
  v_min_u32 v24, v24, v27
  ds_read_b64_tr_b16 v[224:225], v18 offset:36864
  ds_read_b64_tr_b16 v[226:227], v18 offset:37376
  v_mfma_f32_32x32x16_bf16 v[160:175], v[236:239], v[116:119], v[160:175]
  v_cmp_gt_u32 vcc, 40, v24
  ds_read_b64_tr_b16 v[228:229], v19 offset:36864
  ds_read_b64_tr_b16 v[230:231], v19 offset:37376
  s_waitcnt lgkmcnt(10)
  v_mfma_f32_32x32x16_bf16 v[144:159], v[208:211], v[64:67], v[144:159]
  v_mov_b32 v29, 6
  ds_write_b32 v13, v29
  s_cbranch_vccnz Lspin_17
Lok_16:
  ds_read_b128 v[72:75], v8 offset:16384
  ds_read_b128 v[128:131], v9 offset:16384
  s_getreg_b32 s3, hwreg(HW_REG_IB_STS)
  s_and_b32 s3, s3, 0x00c0000f
  s_or_b32 s3, s3, s7
  s_cbranch_scc1 Ltf_43
  s_mov_b64 exec, 1
  buffer_store_dword v28, v15, s[48:51], s69 offen sc1
  s_mov_b64 exec, -1
  s_mov_b32 s7, 1
Ltf_43:
  ds_read_b64_tr_b16 v[232:233], v18 offset:38912
  ds_read_b64_tr_b16 v[234:235], v18 offset:39424
  s_waitcnt lgkmcnt(13)
  v_mfma_f32_32x32x16_bf16 v[160:175], v[212:215], v[64:67], v[160:175]
  ds_read_b128 v[76:79], v10 offset:16384
  ds_read_b128 v[132:135], v11 offset:16384
  ds_read_b64_tr_b16 v[236:237], v19 offset:38912
  ds_read_b64_tr_b16 v[238:239], v19 offset:39424
  s_waitcnt lgkmcnt(15)
  v_mfma_f32_32x32x16_bf16 v[144:159], v[216:219], v[120:123], v[144:159]
  ds_read_b128 v[24:27], v12 offset:16
  ds_read_b64_tr_b16 v[208:209], v18 offset:40960
  ds_read_b64_tr_b16 v[210:211], v18 offset:41472
  s_waitcnt lgkmcnt(15)
  v_mfma_f32_32x32x16_bf16 v[160:175], v[220:223], v[120:123], v[160:175]
  ds_read_b64_tr_b16 v[212:213], v19 offset:40960
  ds_read_b64_tr_b16 v[214:215], v19 offset:41472
  s_waitcnt lgkmcnt(15)
  v_mfma_f32_32x32x16_bf16 v[144:159], v[224:227], v[68:71], v[144:159]
  s_getreg_b32 s3, hwreg(HW_REG_IB_STS)
  s_and_b32 s3, s3, 0x00c0000f
  s_or_b32 s3, s3, s7
  s_cbranch_scc1 Ltf_44
  s_mov_b64 exec, 1
  buffer_store_dword v28, v15, s[48:51], s69 offen sc1
  s_mov_b64 exec, -1
  s_mov_b32 s7, 1
Ltf_44:
  ds_read_b64_tr_b16 v[216:217], v18 offset:43008
  ds_read_b64_tr_b16 v[218:219], v18 offset:43520
  s_waitcnt lgkmcnt(15)
  v_mfma_f32_32x32x16_bf16 v[160:175], v[228:231], v[68:71], v[160:175]
  s_waitcnt lgkmcnt(6)
  v_min3_u32 v24, v24, v25, v26
  ds_read_b64_tr_b16 v[220:221], v19 offset:43008
  ds_read_b64_tr_b16 v[222:223], v19 offset:43520
  v_mfma_f32_32x32x16_bf16 v[144:159], v[232:235], v[124:127], v[144:159]
  v_min_u32 v24, v24, v27
  ds_read_b64_tr_b16 v[224:225], v18 offset:45056
  ds_read_b64_tr_b16 v[226:227], v18 offset:45568
  v_mfma_f32_32x32x16_bf16 v[160:175], v[236:239], v[124:127], v[160:175]
  v_cmp_gt_u32 vcc, 46, v24
  ds_read_b64_tr_b16 v[228:229], v19 offset:45056
  ds_read_b64_tr_b16 v[230:231], v19 offset:45568
  s_waitcnt lgkmcnt(10)
  v_mfma_f32_32x32x16_bf16 v[144:159], v[208:211], v[72:75], v[144:159]
  v_mov_b32 v29, 7
  ds_write_b32 v13, v29
  s_cbranch_vccnz Lspin_19
Lok_18:
  ds_read_b128 v[80:83], v8 offset:32768
  ds_read_b128 v[136:139], v9 offset:32768
  s_getreg_b32 s3, hwreg(HW_REG_IB_STS)
  s_and_b32 s3, s3, 0x00c0000f
  s_or_b32 s3, s3, s7
  s_cbranch_scc1 Ltf_45
  s_mov_b64 exec, 1
  buffer_store_dword v28, v15, s[48:51], s69 offen sc1
  s_mov_b64 exec, -1
  s_mov_b32 s7, 1
Ltf_45:
  ds_read_b64_tr_b16 v[232:233], v18 offset:47104
  ds_read_b64_tr_b16 v[234:235], v18 offset:47616
  s_waitcnt lgkmcnt(13)
  v_mfma_f32_32x32x16_bf16 v[160:175], v[212:215], v[72:75], v[160:175]
  ds_read_b128 v[84:87], v10 offset:32768
  ds_read_b128 v[140:143], v11 offset:32768
  ds_read_b64_tr_b16 v[236:237], v19 offset:47104
  ds_read_b64_tr_b16 v[238:239], v19 offset:47616
  s_waitcnt lgkmcnt(15)
  v_mfma_f32_32x32x16_bf16 v[144:159], v[216:219], v[128:131], v[144:159]
  ds_read_b64_tr_b16 v[208:209], v18 offset:49152
  ds_read_b64_tr_b16 v[210:211], v18 offset:49664
  s_waitcnt lgkmcnt(15)
  v_mfma_f32_32x32x16_bf16 v[160:175], v[220:223], v[128:131], v[160:175]
  ds_read_b64_tr_b16 v[212:213], v19 offset:49152
  ds_read_b64_tr_b16 v[214:215], v19 offset:49664
  s_waitcnt lgkmcnt(15)
  v_mfma_f32_32x32x16_bf16 v[144:159], v[224:227], v[76:79], v[144:159]
  ds_read_b128 v[24:27], v12 offset:16
  s_getreg_b32 s3, hwreg(HW_REG_IB_STS)
  s_and_b32 s3, s3, 0x00c0000f
  s_or_b32 s3, s3, s7
  s_cbranch_scc1 Ltf_46
  s_mov_b64 exec, 1
  buffer_store_dword v28, v15, s[48:51], s69 offen sc1
  s_mov_b64 exec, -1
  s_mov_b32 s7, 1
Ltf_46:
  ds_read_b64_tr_b16 v[216:217], v18 offset:51200
  ds_read_b64_tr_b16 v[218:219], v18 offset:51712
  s_waitcnt lgkmcnt(15)
  v_mfma_f32_32x32x16_bf16 v[160:175], v[228:231], v[76:79], v[160:175]
  ds_read_b64_tr_b16 v[220:221], v19 offset:51200
  ds_read_b64_tr_b16 v[222:223], v19 offset:51712
  s_waitcnt lgkmcnt(13)
  v_mfma_f32_32x32x16_bf16 v[144:159], v[232:235], v[132:135], v[144:159]
  ds_read_b64_tr_b16 v[224:225], v18 offset:53248
  ds_read_b64_tr_b16 v[226:227], v18 offset:53760
  s_waitcnt lgkmcnt(11)
  v_mfma_f32_32x32x16_bf16 v[160:175], v[236:239], v[132:135], v[160:175]
  s_waitcnt lgkmcnt(6)
  v_min3_u32 v24, v24, v25, v26
  ds_read_b64_tr_b16 v[228:229], v19 offset:53248
  ds_read_b64_tr_b16 v[230:231], v19 offset:53760
  v_mfma_f32_32x32x16_bf16 v[144:159], v[208:211], v[80:83], v[144:159]
  v_mov_b32 v29, 8
  ds_write_b32 v13, v29
  v_min_u32 v24, v24, v27
  s_getreg_b32 s3, hwreg(HW_REG_IB_STS)
  s_and_b32 s3, s3, 0x00c0000f
  s_or_b32 s3, s3, s7
  s_cbranch_scc1 Ltf_47
  s_mov_b64 exec, 1
  buffer_store_dword v28, v15, s[48:51], s69 offen sc1
  s_mov_b64 exec, -1
  s_mov_b32 s7, 1
Ltf_47:
  ds_read_b64_tr_b16 v[232:233], v18 offset:55296
  ds_read_b64_tr_b16 v[234:235], v18 offset:55808
  v_mfma_f32_32x32x16_bf16 v[160:175], v[212:215], v[80:83], v[160:175]
  v_cmp_gt_u32 vcc, 48, v24
  ds_read_b64_tr_b16 v[236:237], v19 offset:55296
  ds_read_b64_tr_b16 v[238:239], v19 offset:55808
  s_waitcnt lgkmcnt(11)
  v_mfma_f32_32x32x16_bf16 v[144:159], v[216:219], v[136:139], v[144:159]
  s_cbranch_vccnz Lspin_21
Lok_20:
  ds_read_b64_tr_b16 v[208:209], v20 offset:0
  ds_read_b64_tr_b16 v[210:211], v20 offset:512
  s_waitcnt lgkmcnt(11)
  v_mfma_f32_32x32x16_bf16 v[160:175], v[220:223], v[136:139], v[160:175]
  ds_read_b64_tr_b16 v[212:213], v21 offset:0
  ds_read_b64_tr_b16 v[214:215], v21 offset:512
  s_waitcnt lgkmcnt(11)
  v_mfma_f32_32x32x16_bf16 v[144:159], v[224:227], v[84:87], v[144:159]
  ds_read_b128 v[24:27], v12 offset:16
  s_getreg_b32 s3, hwreg(HW_REG_IB_STS)
  s_and_b32 s3, s3, 0x00c0000f
  s_or_b32 s3, s3, s7
  s_cbranch_scc1 Ltf_48
  s_mov_b64 exec, 1
  buffer_store_dword v28, v15, s[48:51], s69 offen sc1
  s_mov_b64 exec, -1
  s_mov_b32 s7, 1
Ltf_48:
  ds_read_b64_tr_b16 v[216:217], v20 offset:2048
  ds_read_b64_tr_b16 v[218:219], v20 offset:2560
  s_waitcnt lgkmcnt(12)
  v_mfma_f32_32x32x16_bf16 v[160:175], v[228:231], v[84:87], v[160:175]
  ds_read_b64_tr_b16 v[220:221], v21 offset:2048
  ds_read_b64_tr_b16 v[222:223], v21 offset:2560
  s_waitcnt lgkmcnt(11)
  v_mfma_f32_32x32x16_bf16 v[144:159], v[232:235], v[140:143], v[144:159]
  ds_read_b64_tr_b16 v[224:225], v20 offset:4096
  ds_read_b64_tr_b16 v[226:227], v20 offset:4608
  s_waitcnt lgkmcnt(11)
  v_mfma_f32_32x32x16_bf16 v[160:175], v[236:239], v[140:143], v[160:175]
  s_waitcnt lgkmcnt(6)
  v_min3_u32 v24, v24, v25, v26
  ds_read_b64_tr_b16 v[228:229], v21 offset:4096
  ds_read_b64_tr_b16 v[230:231], v21 offset:4608
  v_mfma_f32_32x32x16_bf16 v[176:191], v[208:211], v[32:35], v[176:191]
  v_mov_b32 v29, 9
  ds_write_b32 v13, v29
  v_min_u32 v24, v24, v27
  s_cmp_lg_u32 s7, 0
  s_cbranch_scc1 Lff_49
  s_waitcnt vmcnt(0)
  s_mov_b64 exec, 1
  buffer_store_dword v28, v15, s[48:51], s69 offen sc1
  s_mov_b64 exec, -1
Lff_49:
  s_mov_b32 s7, 0
  ds_read_b64_tr_b16 v[232:233], v20 offset:6144
  ds_read_b64_tr_b16 v[234:235], v20 offset:6656
  v_mfma_f32_32x32x16_bf16 v[192:207], v[212:215], v[32:35], v[192:207]
  v_cmp_gt_u32 vcc, 50, v24
  ds_read_b64_tr_b16 v[236:237], v21 offset:6144
  ds_read_b64_tr_b16 v[238:239], v21 offset:6656
  s_waitcnt lgkmcnt(11)
  v_mfma_f32_32x32x16_bf16 v[176:191], v[216:219], v[88:91], v[176:191]
  v_max_f32 v248, 0, v144
  s_cbranch_vccnz Lspin_23
Lok_22:
  ds_read_b64_tr_b16 v[208:209], v20 offset:8192
  ds_read_b64_tr_b16 v[210:211], v20 offset:8704
  s_waitcnt lgkmcnt(11)
  v_mfma_f32_32x32x16_bf16 v[192:207], v[220:223], v[88:91], v[192:207]
  v_max_f32 v249, 0, v145
  v_max_f32 v250, 0, v146
  ds_read_b64_tr_b16 v[212:213], v21 offset:8192
  ds_read_b64_tr_b16 v[214:215], v21 offset:8704
  s_waitcnt lgkmcnt(11)
  v_mfma_f32_32x32x16_bf16 v[176:191], v[224:227], v[36:39], v[176:191]
  v_max_f32 v251, 0, v147
  v_mul_f32 v248, v248, v248
  v_mul_f32 v249, v249, v249
  ds_read_b128 v[24:27], v12 offset:16
  ds_read_b64_tr_b16 v[216:217], v20 offset:10240
  ds_read_b64_tr_b16 v[218:219], v20 offset:10752
  s_waitcnt lgkmcnt(12)
  v_mfma_f32_32x32x16_bf16 v[192:207], v[228:231], v[36:39], v[192:207]
  v_mul_f32 v250, v250, v250
  v_mul_f32 v251, v251, v251
  ds_read_b64_tr_b16 v[220:221], v21 offset:10240
  ds_read_b64_tr_b16 v[222:223], v21 offset:10752
  s_waitcnt lgkmcnt(11)
  v_mfma_f32_32x32x16_bf16 v[176:191], v[232:235], v[92:95], v[176:191]
  v_cvt_pk_bf16_f32 v240, v248, v249
  v_cvt_pk_bf16_f32 v241, v250, v251
  v_max_f32 v252, 0, v148
  ds_read_b64_tr_b16 v[224:225], v20 offset:12288
  ds_read_b64_tr_b16 v[226:227], v20 offset:12800
  s_waitcnt lgkmcnt(11)
  v_mfma_f32_32x32x16_bf16 v[192:207], v[236:239], v[92:95], v[192:207]
  v_max_f32 v253, 0, v149
  v_max_f32 v254, 0, v150
  v_max_f32 v255, 0, v151
  s_waitcnt lgkmcnt(6)
  v_min3_u32 v24, v24, v25, v26
  ds_read_b64_tr_b16 v[228:229], v21 offset:12288
  ds_read_b64_tr_b16 v[230:231], v21 offset:12800
  v_mfma_f32_32x32x16_bf16 v[176:191], v[208:211], v[40:43], v[176:191]
  v_mul_f32 v252, v252, v252
  v_mul_f32 v253, v253, v253
  v_mov_b32 v29, 10
  ds_write_b32 v13, v29
  v_min_u32 v24, v24, v27
  ds_read_b64_tr_b16 v[232:233], v20 offset:14336
  ds_read_b64_tr_b16 v[234:235], v20 offset:14848
  v_mfma_f32_32x32x16_bf16 v[192:207], v[212:215], v[40:43], v[192:207]
  v_mul_f32 v254, v254, v254
  v_cmp_gt_u32 vcc, 52, v24
  ds_read_b64_tr_b16 v[236:237], v21 offset:14336
  ds_read_b64_tr_b16 v[238:239], v21 offset:14848
  s_waitcnt lgkmcnt(11)
  v_mfma_f32_32x32x16_bf16 v[176:191], v[216:219], v[96:99], v[176:191]
  v_mul_f32 v255, v255, v255
  v_cvt_pk_bf16_f32 v242, v252, v253
  s_cbranch_vccnz Lspin_25
Lok_24:
  ds_read_b64_tr_b16 v[208:209], v20 offset:16384
  ds_read_b64_tr_b16 v[210:211], v20 offset:16896
  s_waitcnt lgkmcnt(11)
  v_mfma_f32_32x32x16_bf16 v[192:207], v[220:223], v[96:99], v[192:207]
  v_cvt_pk_bf16_f32 v243, v254, v255
  s_add_u32 s63, s72, 0
  buffer_store_dwordx4 v[240:243], v22, s[32:35], s63 offen offset:0 sc1
  ds_read_b64_tr_b16 v[212:213], v21 offset:16384
  ds_read_b64_tr_b16 v[214:215], v21 offset:16896
  s_waitcnt lgkmcnt(11)
  v_mfma_f32_32x32x16_bf16 v[176:191], v[224:227], v[44:47], v[176:191]
  v_max_f32 v248, 0, v152
  v_max_f32 v249, 0, v153
  v_max_f32 v250, 0, v154
  ds_read_b128 v[24:27], v12 offset:16
  ds_read_b64_tr_b16 v[216:217], v20 offset:18432
  ds_read_b64_tr_b16 v[218:219], v20 offset:18944
  s_waitcnt lgkmcnt(12)
  v_mfma_f32_32x32x16_bf16 v[192:207], v[228:231], v[44:47], v[192:207]
  v_max_f32 v251, 0, v155
  v_mul_f32 v248, v248, v248
  ds_read_b64_tr_b16 v[220:221], v21 offset:18432
  ds_read_b64_tr_b16 v[222:223], v21 offset:18944
  s_waitcnt lgkmcnt(11)
  v_mfma_f32_32x32x16_bf16 v[176:191], v[232:235], v[100:103], v[176:191]
  v_mul_f32 v249, v249, v249
  v_mul_f32 v250, v250, v250
  v_mul_f32 v251, v251, v251
  ds_read_b64_tr_b16 v[224:225], v20 offset:20480
  ds_read_b64_tr_b16 v[226:227], v20 offset:20992
  s_waitcnt lgkmcnt(11)
  v_mfma_f32_32x32x16_bf16 v[192:207], v[236:239], v[100:103], v[192:207]
  v_cvt_pk_bf16_f32 v244, v248, v249
  v_cvt_pk_bf16_f32 v245, v250, v251
  v_max_f32 v252, 0, v156
  s_waitcnt lgkmcnt(6)
  v_min3_u32 v24, v24, v25, v26
  ds_read_b64_tr_b16 v[228:229], v21 offset:20480
  ds_read_b64_tr_b16 v[230:231], v21 offset:20992
  v_mfma_f32_32x32x16_bf16 v[176:191], v[208:211], v[48:51], v[176:191]
  v_max_f32 v253, 0, v157
  v_max_f32 v254, 0, v158
  v_mov_b32 v29, 11
  ds_write_b32 v13, v29
  v_min_u32 v24, v24, v27
  ds_read_b64_tr_b16 v[232:233], v20 offset:22528
  ds_read_b64_tr_b16 v[234:235], v20 offset:23040
  v_mfma_f32_32x32x16_bf16 v[192:207], v[212:215], v[48:51], v[192:207]
  v_max_f32 v255, 0, v159
  v_cmp_gt_u32 vcc, 54, v24
  ds_read_b64_tr_b16 v[236:237], v21 offset:22528
  ds_read_b64_tr_b16 v[238:239], v21 offset:23040
  s_waitcnt lgkmcnt(11)
  v_mfma_f32_32x32x16_bf16 v[176:191], v[216:219], v[104:107], v[176:191]
  v_mul_f32 v252, v252, v252
  v_mul_f32 v253, v253, v253
  s_cbranch_vccnz Lspin_27
Lok_26:
  ds_read_b64_tr_b16 v[208:209], v16 offset:49152
  ds_read_b64_tr_b16 v[210:211], v16 offset:49664
  s_waitcnt lgkmcnt(11)
  v_mfma_f32_32x32x16_bf16 v[192:207], v[220:223], v[104:107], v[192:207]
  v_mul_f32 v254, v254, v254
  v_mul_f32 v255, v255, v255
  ds_read_b64_tr_b16 v[212:213], v17 offset:49152
  ds_read_b64_tr_b16 v[214:215], v17 offset:49664
  s_waitcnt lgkmcnt(11)
  v_mfma_f32_32x32x16_bf16 v[176:191], v[224:227], v[52:55], v[176:191]
  v_cvt_pk_bf16_f32 v246, v252, v253
  v_cvt_pk_bf16_f32 v247, v254, v255
  s_add_u32 s63, s72, 0
  buffer_store_dwordx4 v[244:247], v22, s[32:35], s63 offen offset:512 sc1
  ds_read_b128 v[24:27], v12 offset:16
  ds_read_b64_tr_b16 v[216:217], v16 offset:51200
  ds_read_b64_tr_b16 v[218:219], v16 offset:51712
  s_waitcnt lgkmcnt(12)
  v_mfma_f32_32x32x16_bf16 v[192:207], v[228:231], v[52:55], v[192:207]
  v_max_f32 v248, 0, v160
  v_max_f32 v249, 0, v161
  ds_read_b64_tr_b16 v[220:221], v17 offset:51200
  ds_read_b64_tr_b16 v[222:223], v17 offset:51712
  s_waitcnt lgkmcnt(11)
  v_mfma_f32_32x32x16_bf16 v[176:191], v[232:235], v[108:111], v[176:191]
  v_max_f32 v250, 0, v162
  v_max_f32 v251, 0, v163
  v_mul_f32 v248, v248, v248
  ds_read_b64_tr_b16 v[224:225], v16 offset:53248
  ds_read_b64_tr_b16 v[226:227], v16 offset:53760
  s_waitcnt lgkmcnt(11)
  v_mfma_f32_32x32x16_bf16 v[192:207], v[236:239], v[108:111], v[192:207]
  v_mul_f32 v249, v249, v249
  v_mul_f32 v250, v250, v250
  v_mul_f32 v251, v251, v251
  s_waitcnt lgkmcnt(6)
  v_min3_u32 v24, v24, v25, v26
  ds_read_b64_tr_b16 v[228:229], v17 offset:53248
  ds_read_b64_tr_b16 v[230:231], v17 offset:53760
  v_mfma_f32_32x32x16_bf16 v[176:191], v[208:211], v[56:59], v[176:191]
  v_cvt_pk_bf16_f32 v240, v248, v249
  v_cvt_pk_bf16_f32 v241, v250, v251
  v_mov_b32 v29, 12
  ds_write_b32 v13, v29
  v_min_u32 v24, v24, v27
  ds_read_b64_tr_b16 v[232:233], v16 offset:55296
  ds_read_b64_tr_b16 v[234:235], v16 offset:55808
  v_mfma_f32_32x32x16_bf16 v[192:207], v[212:215], v[56:59], v[192:207]
  v_max_f32 v252, 0, v164
  v_cmp_gt_u32 vcc, 57, v24
  ds_read_b64_tr_b16 v[236:237], v17 offset:55296
  ds_read_b64_tr_b16 v[238:239], v17 offset:55808
  s_waitcnt lgkmcnt(11)
  v_mfma_f32_32x32x16_bf16 v[176:191], v[216:219], v[112:115], v[176:191]
  v_max_f32 v253, 0, v165
  v_max_f32 v254, 0, v166
  s_cbranch_vccnz Lspin_29
Lok_28:
  ds_read_b64_tr_b16 v[208:209], v16 offset:57344
  ds_read_b64_tr_b16 v[210:211], v16 offset:57856
  s_waitcnt lgkmcnt(11)
  v_mfma_f32_32x32x16_bf16 v[192:207], v[220:223], v[112:115], v[192:207]
  v_max_f32 v255, 0, v167
  v_mul_f32 v252, v252, v252
  ds_read_b64_tr_b16 v[212:213], v17 offset:57344
  ds_read_b64_tr_b16 v[214:215], v17 offset:57856
  s_waitcnt lgkmcnt(11)
  v_mfma_f32_32x32x16_bf16 v[176:191], v[224:227], v[60:63], v[176:191]
  v_mul_f32 v253, v253, v253
  v_mul_f32 v254, v254, v254
  v_mul_f32 v255, v255, v255
  ds_read_b128 v[24:27], v12 offset:16
  ds_read_b64_tr_b16 v[216:217], v16 offset:59392
  ds_read_b64_tr_b16 v[218:219], v16 offset:59904
  s_waitcnt lgkmcnt(12)
  v_mfma_f32_32x32x16_bf16 v[192:207], v[228:231], v[60:63], v[192:207]
  v_cvt_pk_bf16_f32 v242, v252, v253
  v_cvt_pk_bf16_f32 v243, v254, v255
  ds_read_b64_tr_b16 v[220:221], v17 offset:59392
  ds_read_b64_tr_b16 v[222:223], v17 offset:59904
  s_waitcnt lgkmcnt(11)
  v_mfma_f32_32x32x16_bf16 v[176:191], v[232:235], v[116:119], v[176:191]
  s_add_u32 s63, s72, 4096
  buffer_store_dwordx4 v[240:243], v22, s[32:35], s63 offen offset:0 sc1
  v_max_f32 v248, 0, v168
  v_max_f32 v249, 0, v169
  ds_read_b64_tr_b16 v[224:225], v16 offset:61440
  ds_read_b64_tr_b16 v[226:227], v16 offset:61952
  s_waitcnt lgkmcnt(11)
  v_mfma_f32_32x32x16_bf16 v[192:207], v[236:239], v[116:119], v[192:207]
  v_max_f32 v250, 0, v170
  v_max_f32 v251, 0, v171
  v_mul_f32 v248, v248, v248
  s_waitcnt lgkmcnt(6)
  v_min3_u32 v24, v24, v25, v26
  ds_read_b64_tr_b16 v[228:229], v17 offset:61440
  ds_read_b64_tr_b16 v[230:231], v17 offset:61952
  v_mfma_f32_32x32x16_bf16 v[176:191], v[208:211], v[64:67], v[176:191]
  v_mul_f32 v249, v249, v249
  v_mul_f32 v250, v250, v250
  v_mov_b32 v29, 13
  ds_write_b32 v13, v29
  v_min_u32 v24, v24, v27
  ds_read_b64_tr_b16 v[232:233], v16 offset:63488
  ds_read_b64_tr_b16 v[234:235], v16 offset:64000
  v_mfma_f32_32x32x16_bf16 v[192:207], v[212:215], v[64:67], v[192:207]
  v_mul_f32 v251, v251, v251
  v_cmp_gt_u32 vcc, 59, v24
  ds_read_b64_tr_b16 v[236:237], v17 offset:63488
  ds_read_b64_tr_b16 v[238:239], v17 offset:64000
  s_waitcnt lgkmcnt(11)
  v_mfma_f32_32x32x16_bf16 v[176:191], v[216:219], v[120:123], v[176:191]
  v_cvt_pk_bf16_f32 v244, v248, v249
  v_cvt_pk_bf16_f32 v245, v250, v251
  s_cbranch_vccnz Lspin_31
Lok_30:
  ds_read_b64_tr_b16 v[208:209], v16 offset:0
  ds_read_b64_tr_b16 v[210:211], v16 offset:512
  s_waitcnt lgkmcnt(11)
  v_mfma_f32_32x32x16_bf16 v[192:207], v[220:223], v[120:123], v[192:207]
  v_max_f32 v252, 0, v172
  v_max_f32 v253, 0, v173
  ds_read_b64_tr_b16 v[212:213], v17 offset:0
  ds_read_b64_tr_b16 v[214:215], v17 offset:512
  s_waitcnt lgkmcnt(11)
  v_mfma_f32_32x32x16_bf16 v[176:191], v[224:227], v[68:71], v[176:191]
  v_max_f32 v254, 0, v174
  v_max_f32 v255, 0, v175
  v_mul_f32 v252, v252, v252
  ds_read_b128 v[24:27], v12 offset:16
  ds_read_b64_tr_b16 v[216:217], v16 offset:2048
  ds_read_b64_tr_b16 v[218:219], v16 offset:2560
  s_waitcnt lgkmcnt(12)
  v_mfma_f32_32x32x16_bf16 v[192:207], v[228:231], v[68:71], v[192:207]
  v_mul_f32 v253, v253, v253
  v_mul_f32 v254, v254, v254
  ds_read_b64_tr_b16 v[220:221], v17 offset:2048
  ds_read_b64_tr_b16 v[222:223], v17 offset:2560
  s_waitcnt lgkmcnt(11)
  v_mfma_f32_32x32x16_bf16 v[176:191], v[232:235], v[124:127], v[176:191]
  v_mul_f32 v255, v255, v255
  v_cvt_pk_bf16_f32 v246, v252, v253
  v_cvt_pk_bf16_f32 v247, v254, v255
  ds_read_b64_tr_b16 v[224:225], v16 offset:4096
  ds_read_b64_tr_b16 v[226:227], v16 offset:4608
  s_waitcnt lgkmcnt(11)
  v_mfma_f32_32x32x16_bf16 v[192:207], v[236:239], v[124:127], v[192:207]
  s_add_u32 s63, s72, 4096
  buffer_store_dwordx4 v[244:247], v22, s[32:35], s63 offen offset:512 sc1
  s_waitcnt lgkmcnt(6)
  v_min3_u32 v24, v24, v25, v26
  ds_read_b64_tr_b16 v[228:229], v17 offset:4096
  ds_read_b64_tr_b16 v[230:231], v17 offset:4608
  v_mfma_f32_32x32x16_bf16 v[176:191], v[208:211], v[72:75], v[176:191]
  s_getreg_b32 s3, hwreg(HW_REG_IB_STS)
  s_and_b32 s3, s3, 0x00c0000f
  s_or_b32 s3, s3, s7
  s_cbranch_scc1 Ltf_50
  s_mov_b64 exec, 1
  buffer_store_dword v28, v15, s[32:35], s6 offen sc1
  s_mov_b64 exec, -1
  s_mov_b32 s7, 1
Ltf_50:
  v_mov_b32 v29, 14
  ds_write_b32 v13, v29
  v_min_u32 v24, v24, v27
  ds_read_b64_tr_b16 v[232:233], v16 offset:6144
  ds_read_b64_tr_b16 v[234:235], v16 offset:6656
  v_mfma_f32_32x32x16_bf16 v[192:207], v[212:215], v[72:75], v[192:207]
  v_permlane16_swap_b32 v32, v88
  v_cmp_gt_u32 vcc, 61, v24
  ds_read_b64_tr_b16 v[236:237], v17 offset:6144
  ds_read_b64_tr_b16 v[238:239], v17 offset:6656
  s_waitcnt lgkmcnt(11)
  v_mfma_f32_32x32x16_bf16 v[176:191], v[216:219], v[128:131], v[176:191]
  v_permlane16_swap_b32 v33, v89
  s_cbranch_vccnz Lspin_33
Lok_32:
  ds_read_b64_tr_b16 v[208:209], v16 offset:8192
  ds_read_b64_tr_b16 v[210:211], v16 offset:8704
  s_waitcnt lgkmcnt(11)
  v_mfma_f32_32x32x16_bf16 v[192:207], v[220:223], v[128:131], v[192:207]
  v_permlane16_swap_b32 v34, v90
  ds_read_b64_tr_b16 v[212:213], v17 offset:8192
  ds_read_b64_tr_b16 v[214:215], v17 offset:8704
  s_waitcnt lgkmcnt(11)
  v_mfma_f32_32x32x16_bf16 v[176:191], v[224:227], v[76:79], v[176:191]
  s_getreg_b32 s3, hwreg(HW_REG_IB_STS)
  s_and_b32 s3, s3, 0x00c0000f
  s_or_b32 s3, s3, s7
  s_cbranch_scc1 Ltf_51
  s_mov_b64 exec, 1
  buffer_store_dword v28, v15, s[32:35], s6 offen sc1
  s_mov_b64 exec, -1
  s_mov_b32 s7, 1
Ltf_51:
  ds_read_b64_tr_b16 v[216:217], v16 offset:10240
  ds_read_b64_tr_b16 v[218:219], v16 offset:10752
  s_waitcnt lgkmcnt(11)
  v_mfma_f32_32x32x16_bf16 v[192:207], v[228:231], v[76:79], v[192:207]
  v_permlane16_swap_b32 v35, v91
  ds_read_b64_tr_b16 v[220:221], v17 offset:10240
  ds_read_b64_tr_b16 v[222:223], v17 offset:10752
  s_waitcnt lgkmcnt(10)
  v_mfma_f32_32x32x16_bf16 v[176:191], v[232:235], v[132:135], v[176:191]
  v_permlane16_swap_b32 v36, v92
  ds_read_b64_tr_b16 v[224:225], v16 offset:12288
  ds_read_b64_tr_b16 v[226:227], v16 offset:12800
  s_waitcnt lgkmcnt(10)
  v_mfma_f32_32x32x16_bf16 v[192:207], v[236:239], v[132:135], v[192:207]
  v_permlane16_swap_b32 v37, v93
  ds_read_b64_tr_b16 v[228:229], v17 offset:12288
  ds_read_b64_tr_b16 v[230:231], v17 offset:12800
  s_waitcnt lgkmcnt(10)
  v_mfma_f32_32x32x16_bf16 v[176:191], v[208:211], v[80:83], v[176:191]
  s_getreg_b32 s3, hwreg(HW_REG_IB_STS)
  s_and_b32 s3, s3, 0x00c0000f
  s_or_b32 s3, s3, s7
  s_cbranch_scc1 Ltf_52
  s_mov_b64 exec, 1
  buffer_store_dword v28, v15, s[32:35], s6 offen sc1
  s_mov_b64 exec, -1
  s_mov_b32 s7, 1
Ltf_52:
  v_mov_b32 v29, 15
  ds_write_b32 v13, v29
  ds_read_b64_tr_b16 v[232:233], v16 offset:14336
  ds_read_b64_tr_b16 v[234:235], v16 offset:14848
  s_waitcnt lgkmcnt(11)
  v_mfma_f32_32x32x16_bf16 v[192:207], v[212:215], v[80:83], v[192:207]
  v_permlane16_swap_b32 v38, v94
  ds_read_b64_tr_b16 v[236:237], v17 offset:14336
  ds_read_b64_tr_b16 v[238:239], v17 offset:14848
  s_waitcnt lgkmcnt(11)
  v_mfma_f32_32x32x16_bf16 v[176:191], v[216:219], v[136:139], v[176:191]
  v_permlane16_swap_b32 v39, v95
  s_waitcnt lgkmcnt(9)
  v_mfma_f32_32x32x16_bf16 v[192:207], v[220:223], v[136:139], v[192:207]
  v_permlane16_swap_b32 v40, v96
  s_waitcnt lgkmcnt(7)
  v_mfma_f32_32x32x16_bf16 v[176:191], v[224:227], v[84:87], v[176:191]
  s_getreg_b32 s3, hwreg(HW_REG_IB_STS)
  s_and_b32 s3, s3, 0x00c0000f
  s_or_b32 s3, s3, s7
  s_cbranch_scc1 Ltf_53
  s_mov_b64 exec, 1
  buffer_store_dword v28, v15, s[32:35], s6 offen sc1
  s_mov_b64 exec, -1
  s_mov_b32 s7, 1
Ltf_53:
  s_waitcnt lgkmcnt(5)
  v_mfma_f32_32x32x16_bf16 v[192:207], v[228:231], v[84:87], v[192:207]
  v_permlane16_swap_b32 v41, v97
  s_waitcnt lgkmcnt(2)
  v_mfma_f32_32x32x16_bf16 v[176:191], v[232:235], v[140:143], v[176:191]
  v_permlane16_swap_b32 v42, v98
  s_waitcnt lgkmcnt(0)
  v_mfma_f32_32x32x16_bf16 v[192:207], v[236:239], v[140:143], v[192:207]
  v_permlane16_swap_b32 v43, v99
  v_mov_b32 v29, 16
  ds_write_b32 v13, v29
  s_cmp_lg_u32 s7, 0
  s_cbranch_scc1 Lff_54
  s_waitcnt vmcnt(0)
  s_mov_b64 exec, 1
  buffer_store_dword v28, v15, s[32:35], s6 offen sc1
  s_mov_b64 exec, -1
Lff_54:
  s_mov_b32 s7, 0
  s_nop 7
  v_max_f32 v248, 0, v176
  v_max_f32 v249, 0, v177
  v_max_f32 v250, 0, v178
  v_max_f32 v251, 0, v179
  v_mul_f32 v248, v248, v248
  v_mul_f32 v249, v249, v249
  v_mul_f32 v250, v250, v250
  v_mul_f32 v251, v251, v251
  v_cvt_pk_bf16_f32 v240, v248, v249
  v_cvt_pk_bf16_f32 v241, v250, v251
  v_max_f32 v252, 0, v180
  v_max_f32 v253, 0, v181
  v_max_f32 v254, 0, v182
  v_max_f32 v255, 0, v183
  v_mul_f32 v252, v252, v252
  v_mul_f32 v253, v253, v253
  v_mul_f32 v254, v254, v254
  v_mul_f32 v255, v255, v255
  v_cvt_pk_bf16_f32 v242, v252, v253
  v_cvt_pk_bf16_f32 v243, v254, v255
  s_add_u32 s63, s72, 114688
  buffer_store_dwordx4 v[240:243], v22, s[32:35], s63 offen offset:0 sc1
  v_max_f32 v248, 0, v184
  v_max_f32 v249, 0, v185
  v_max_f32 v250, 0, v186
  v_max_f32 v251, 0, v187
  v_mul_f32 v248, v248, v248
  v_mul_f32 v249, v249, v249
  v_mul_f32 v250, v250, v250
  v_mul_f32 v251, v251, v251
  v_cvt_pk_bf16_f32 v244, v248, v249
  v_cvt_pk_bf16_f32 v245, v250, v251
  v_max_f32 v252, 0, v188
  v_max_f32 v253, 0, v189
  v_max_f32 v254, 0, v190
  v_max_f32 v255, 0, v191
  v_mul_f32 v252, v252, v252
  v_mul_f32 v253, v253, v253
  v_mul_f32 v254, v254, v254
  v_mul_f32 v255, v255, v255
  v_cvt_pk_bf16_f32 v246, v252, v253
  v_cvt_pk_bf16_f32 v247, v254, v255
  s_add_u32 s63, s72, 114688
  buffer_store_dwordx4 v[244:247], v22, s[32:35], s63 offen offset:512 sc1
  v_max_f32 v248, 0, v192
  v_max_f32 v249, 0, v193
  v_max_f32 v250, 0, v194
  v_max_f32 v251, 0, v195
  v_mul_f32 v248, v248, v248
  v_mul_f32 v249, v249, v249
  v_mul_f32 v250, v250, v250
  v_mul_f32 v251, v251, v251
  v_cvt_pk_bf16_f32 v240, v248, v249
  v_cvt_pk_bf16_f32 v241, v250, v251
  v_max_f32 v252, 0, v196
  v_max_f32 v253, 0, v197
  v_max_f32 v254, 0, v198
  v_max_f32 v255, 0, v199
  v_mul_f32 v252, v252, v252
  v_mul_f32 v253, v253, v253
  v_mul_f32 v254, v254, v254
  v_mul_f32 v255, v255, v255
  v_cvt_pk_bf16_f32 v242, v252, v253
  v_cvt_pk_bf16_f32 v243, v254, v255
  s_add_u32 s63, s72, 118784
  buffer_store_dwordx4 v[240:243], v22, s[32:35], s63 offen offset:0 sc1
  v_max_f32 v248, 0, v200
  v_max_f32 v249, 0, v201
  v_max_f32 v250, 0, v202
  v_max_f32 v251, 0, v203
  v_mul_f32 v248, v248, v248
  v_mul_f32 v249, v249, v249
  v_mul_f32 v250, v250, v250
  v_mul_f32 v251, v251, v251
  v_cvt_pk_bf16_f32 v244, v248, v249
  v_cvt_pk_bf16_f32 v245, v250, v251
  v_max_f32 v252, 0, v204
  v_max_f32 v253, 0, v205
  v_max_f32 v254, 0, v206
  v_max_f32 v255, 0, v207
  v_mul_f32 v252, v252, v252
  v_mul_f32 v253, v253, v253
  v_mul_f32 v254, v254, v254
  v_mul_f32 v255, v255, v255
  v_cvt_pk_bf16_f32 v246, v252, v253
  v_cvt_pk_bf16_f32 v247, v254, v255
  s_add_u32 s63, s72, 118784
  buffer_store_dwordx4 v[244:247], v22, s[32:35], s63 offen offset:512 sc1
  v_permlane16_swap_b32 v44, v100
  v_permlane16_swap_b32 v45, v101
  v_permlane16_swap_b32 v46, v102
  v_permlane16_swap_b32 v47, v103
  v_permlane16_swap_b32 v48, v104
  v_permlane16_swap_b32 v49, v105
  v_permlane16_swap_b32 v50, v106
  v_permlane16_swap_b32 v51, v107
  v_permlane16_swap_b32 v52, v108
  v_permlane16_swap_b32 v53, v109
  v_permlane16_swap_b32 v54, v110
  v_permlane16_swap_b32 v55, v111
  v_permlane16_swap_b32 v56, v112
  v_permlane16_swap_b32 v57, v113
  v_permlane16_swap_b32 v58, v114
  v_permlane16_swap_b32 v59, v115
  v_permlane16_swap_b32 v60, v116
  v_permlane16_swap_b32 v61, v117
  v_permlane16_swap_b32 v62, v118
  v_permlane16_swap_b32 v63, v119
  v_permlane16_swap_b32 v64, v120
  v_permlane16_swap_b32 v65, v121
  v_permlane16_swap_b32 v66, v122
  v_permlane16_swap_b32 v67, v123
  v_permlane16_swap_b32 v68, v124
  v_permlane16_swap_b32 v69, v125
  v_permlane16_swap_b32 v70, v126
  v_permlane16_swap_b32 v71, v127
  v_permlane16_swap_b32 v72, v128
  v_permlane16_swap_b32 v73, v129
  v_permlane16_swap_b32 v74, v130
  v_permlane16_swap_b32 v75, v131
  v_permlane16_swap_b32 v76, v132
  v_permlane16_swap_b32 v77, v133
  v_permlane16_swap_b32 v78, v134
  v_permlane16_swap_b32 v79, v135
  v_permlane16_swap_b32 v80, v136
  v_permlane16_swap_b32 v81, v137
  v_permlane16_swap_b32 v82, v138
  v_permlane16_swap_b32 v83, v139
  v_permlane16_swap_b32 v84, v140
  v_permlane16_swap_b32 v85, v141
  v_permlane16_swap_b32 v86, v142
  v_permlane16_swap_b32 v87, v143
  s_add_u32 s6, s6, 131072
  s_branch L_p1_b
L_p1_noa:
  v_mov_b32 v28, s67
  s_mov_b32 s7, 1
  s_sub_u32 s60, s68, 1
  s_cmp_ge_u32 s60, 2
  s_cbranch_scc1 Lsk_55
  v_lshrrev_b32 v1, 4, v0
  v_bfe_u32 v2, v0, 2, 2
  v_and_b32 v3, 3, v0
  s_lshl_b32 s60, s2, 1
  s_add_u32 s60, s60, s68
  s_sub_u32 s60, s60, 1
  s_cmp_lt_u32 s60, 504
  s_mov_b32 s48, s32
  s_mov_b32 s49, s33
  s_cselect_b32 s50, s34, 0
  s_mov_b32 s51, 0x00020000
  s_min_u32 s60, s60, 503
  s_mul_i32 s61, s60, 911
  s_lshr_b32 s61, s61, 16
  s_mul_i32 s62, s61, 72
  s_sub_u32 s62, s60, s62
  s_cmp_lt_u32 s62, 56
  s_cselect_b32 s40, s20, s12
  s_cselect_b32 s41, s21, s13
  s_mov_b32 s63, 1605632
  s_mov_b32 s64, 401408
  s_cselect_b32 s42, s63, s64
  s_mov_b32 s43, 0x00020000
  s_cselect_b64 vcc, 0, -1
  s_cmp_ge_u32 s62, 28
  s_cselect_b32 s64, 28, 0
  s_cselect_b32 s65, 64, 0
  s_sub_u32 s64, s62, s64
  s_lshr_b32 s63, s64, 1
  s_lshl_b32 s63, s63, 7
  s_add_u32 s63, s63, s65
  s_and_b32 s64, s64, 1
  s_lshl_b32 s64, s64, 5
  s_add_u32 s63, s63, s64
  s_sub_u32 s64, s62, 56
  s_mul_i32 s64, s64, 28
  s_cmp_lt_u32 s62, 56
  s_cselect_b32 s63, s63, s64
  s_and_b32 s41, s41, 0xffff
  s_mul_i32 s63, s63, 896
  s_lshl_b32 s64, s61, 7
  s_add_u32 s63, s63, s64
  v_and_b32 v4, 1, v1
  v_lshrrev_b32 v5, 1, v1
  v_lshlrev_b32 v4, 2, v4
  v_lshl_add_u32 v4, v5, 4, v4
  v_lshlrev_b32 v5, 2, v1
  v_cndmask_b32 v6, v4, v5, vcc
  v_mov_b32 v4, 1024
  v_mov_b32 v5, 2048
  v_cndmask_b32 v7, v4, v5, vcc
  v_lshrrev_b32 v4, 3, v0
  v_mul_u32_u24 v4, 896, v4
  v_and_b32 v5, 7, v0
  v_lshl_add_u32 v4, v5, 4, v4
  s_mov_b32 vcc_lo, 0
  v_mov_b32 v5, 0x40000000
  s_nop 1
  v_cndmask_b32 v5, v4, v5, vcc
  s_lshl_b32 s64, s68, 12
  s_add_u32 m0, s64, 149504
  s_nop 0
  buffer_load_dwordx4 v4, s[40:43], s63 offen offset:0 lds
  s_add_u32 s63, s63, 6144
  buffer_load_dwordx4 v4, s[40:43], s63 offen offset:1024 lds
  s_add_u32 s63, s63, 6144
  buffer_load_dwordx4 v4, s[40:43], s63 offen offset:2048 lds
  s_add_u32 s63, s63, 6144
  buffer_load_dwordx4 v5, s[40:43], s63 offen offset:3072 lds
  v_add_u32 v6, v6, v2
  v_lshlrev_b32 v6, 7, v6
  v_lshl_add_u32 v6, v3, 3, v6
  v_add_u32 v6, m0, v6
  v_add_u32 v7, v6, v7
  s_mul_i32 s63, s62, 9363
  s_lshr_b32 s63, s63, 16
  s_mul_i32 s64, s63, 7
  s_sub_u32 s64, s62, s64
  s_lshr_b32 s65, s63, 2
  s_mul_i32 s65, s65, 7
  s_add_u32 s64, s64, s65
  s_and_b32 s63, s63, 3
  s_sub_u32 s65, s62, 56
  s_lshr_b32 s70, s65, 2
  s_and_b32 s65, s65, 3
  s_add_u32 s65, s65, 14
  s_cmp_lt_u32 s62, 56
  s_cselect_b32 s63, s63, s70
  s_cselect_b32 s64, s64, s65
  s_lshl_b32 s61, s61, 2
  s_add_u32 s61, s61, s63
  s_lshl_b32 s61, s61, 7
  s_lshl_b32 s64, s64, 2
  s_add_u32 s61, s61, s64
  s_add_u32 s69, s61, 13404160
  s_lshl_b32 s74, s60, 12
  s_add_u32 s74, s74, 9437184
Lsk_55:
  s_cmp_lg_u32 s68, 0
  s_cbranch_scc1 Lsk_56
  v_mov_b32 v6, v242
  v_mov_b32 v7, v243
  v_and_b32 v3, 3, v0
  s_waitcnt vmcnt(0)
  v_cmp_eq_u32 vcc, 3, v3
  s_nop 1
  v_cndmask_b32 v66, v66, v240, vcc
  v_cndmask_b32 v67, v67, v15, vcc
  ds_write_b128 v6, v[64:67] offset:0
  v_cndmask_b32 v70, v70, v241, vcc
  v_cndmask_b32 v71, v71, v15, vcc
  ds_write_b128 v6, v[68:71] offset:3072
  v_cndmask_b32 v74, v74, v15, vcc
  v_cndmask_b32 v75, v75, v15, vcc
  ds_write_b128 v6, v[72:75] offset:64
  v_cndmask_b32 v78, v78, v15, vcc
  v_cndmask_b32 v79, v79, v15, vcc
  ds_write_b128 v6, v[76:79] offset:3136
  v_cndmask_b32 v82, v82, v15, vcc
  v_cndmask_b32 v83, v83, v15, vcc
  ds_write_b128 v6, v[80:83] offset:128
  v_cndmask_b32 v86, v86, v15, vcc
  v_cndmask_b32 v87, v87, v15, vcc
  ds_write_b128 v6, v[84:87] offset:3200
  ds_read_b64_tr_b16 v[120:121], v7 offset:0
  ds_read_b64_tr_b16 v[122:123], v7 offset:768
  ds_read_b64_tr_b16 v[124:125], v7 offset:32
  ds_read_b64_tr_b16 v[126:127], v7 offset:800
  ds_read_b64_tr_b16 v[128:129], v7 offset:64
  ds_read_b64_tr_b16 v[130:131], v7 offset:832
  ds_read_b64_tr_b16 v[132:133], v7 offset:96
  ds_read_b64_tr_b16 v[134:135], v7 offset:864
  ds_read_b64_tr_b16 v[136:137], v7 offset:128
  ds_read_b64_tr_b16 v[138:139], v7 offset:896
  ds_read_b64_tr_b16 v[140:141], v7 offset:160
  ds_read_b64_tr_b16 v[142:143], v7 offset:928
  s_waitcnt lgkmcnt(10)
  buffer_store_dwordx4 v[120:123], v14, s[48:51], s74 offen offset:0 sc1
  s_waitcnt lgkmcnt(8)
  buffer_store_dwordx4 v[124:127], v14, s[48:51], s74 offen offset:1024 sc1
  s_waitcnt lgkmcnt(6)
  buffer_store_dwordx4 v[128:131], v14, s[48:51], s74 offen offset:2048 sc1
  s_waitcnt lgkmcnt(4)
  buffer_store_dwordx4 v[132:135], v14, s[48:51], s74 offen offset:3072 sc1
  s_waitcnt lgkmcnt(2)
  buffer_store_dwordx4 v[136:139], v14, s[48:51], s75 offen offset:0 sc1
  s_waitcnt lgkmcnt(0)
  buffer_store_dwordx4 v[140:143], v14, s[48:51], s75 offen offset:1024 sc1
  s_mov_b32 s7, 0
Lsk_56:
  s_sub_u32 s60, s68, 1
  s_cmp_ge_u32 s60, 2
  s_cbranch_scc1 Lsk_57
  s_waitcnt vmcnt(0)
  ds_read_b64_tr_b16 v[240:241], v6 offset:0
  ds_read_b64_tr_b16 v[242:243], v7 offset:0
  ds_read_b64_tr_b16 v[244:245], v6 offset:32
  ds_read_b64_tr_b16 v[246:247], v7 offset:32
  ds_read_b64_tr_b16 v[248:249], v6 offset:64
  ds_read_b64_tr_b16 v[250:251], v7 offset:64
  ds_read_b64_tr_b16 v[252:253], v6 offset:96
  ds_read_b64_tr_b16 v[254:255], v7 offset:96
  s_waitcnt lgkmcnt(6)
  buffer_store_dwordx4 v[240:243], v14, s[48:51], s74 offen offset:0 sc1
  s_waitcnt lgkmcnt(4)
  buffer_store_dwordx4 v[244:247], v14, s[48:51], s74 offen offset:1024 sc1
  s_waitcnt lgkmcnt(2)
  buffer_store_dwordx4 v[248:251], v14, s[48:51], s74 offen offset:2048 sc1
  s_waitcnt lgkmcnt(0)
  buffer_store_dwordx4 v[252:255], v14, s[48:51], s74 offen offset:3072 sc1
  s_mov_b32 s7, 0
Lsk_57:
  ds_read_b128 v[24:27], v12 offset:16
  s_waitcnt lgkmcnt(0)
  v_min3_u32 v24, v24, v25, v26
  v_min_u32 v24, v24, v27
  v_cmp_gt_u32 vcc, 4, v24
  s_cbranch_vccnz Lspin_59
Lok_58:
  ds_read_b128 v[32:35], v8 offset:0
  ds_read_b128 v[88:91], v9 offset:0
  ds_read_b128 v[36:39], v10 offset:0
  ds_read_b128 v[92:95], v11 offset:0
  s_waitcnt lgkmcnt(0)
  v_mov_b32 v29, 2
  ds_write_b32 v13, v29
  v_permlane16_swap_b32 v32, v88
  v_permlane16_swap_b32 v33, v89
  v_permlane16_swap_b32 v34, v90
  v_permlane16_swap_b32 v35, v91
  v_permlane16_swap_b32 v36, v92
  v_permlane16_swap_b32 v37, v93
  v_permlane16_swap_b32 v38, v94
  v_permlane16_swap_b32 v39, v95
  ds_read_b128 v[24:27], v12 offset:16
  s_waitcnt lgkmcnt(0)
  v_min3_u32 v24, v24, v25, v26
  v_min_u32 v24, v24, v27
  v_cmp_gt_u32 vcc, 8, v24
  s_cbranch_vccnz Lspin_61
Lok_60:
  ds_read_b128 v[40:43], v8 offset:16384
  ds_read_b128 v[96:99], v9 offset:16384
  ds_read_b128 v[44:47], v10 offset:16384
  ds_read_b128 v[100:103], v11 offset:16384
  s_waitcnt lgkmcnt(0)
  v_mov_b32 v29, 3
  ds_write_b32 v13, v29
  v_permlane16_swap_b32 v40, v96
  v_permlane16_swap_b32 v41, v97
  v_permlane16_swap_b32 v42, v98
  v_permlane16_swap_b32 v43, v99
  v_permlane16_swap_b32 v44, v100
  v_permlane16_swap_b32 v45, v101
  v_permlane16_swap_b32 v46, v102
  v_permlane16_swap_b32 v47, v103
  s_cmp_lg_u32 s7, 0
  s_cbranch_scc1 Lff_62
  s_waitcnt vmcnt(0)
  s_mov_b64 exec, 1
  buffer_store_dword v28, v15, s[48:51], s69 offen sc1
  s_mov_b64 exec, -1
Lff_62:
  s_mov_b32 s7, 0
  ds_read_b128 v[24:27], v12 offset:16
  s_waitcnt lgkmcnt(0)
  v_min3_u32 v24, v24, v25, v26
  v_min_u32 v24, v24, v27
  v_cmp_gt_u32 vcc, 16, v24
  s_cbranch_vccnz Lspin_64
Lok_63:
  ds_read_b128 v[48:51], v8 offset:32768
  ds_read_b128 v[104:107], v9 offset:32768
  ds_read_b128 v[52:55], v10 offset:32768
  ds_read_b128 v[108:111], v11 offset:32768
  s_waitcnt lgkmcnt(0)
  v_mov_b32 v29, 4
  ds_write_b32 v13, v29
  v_permlane16_swap_b32 v48, v104
  v_permlane16_swap_b32 v49, v105
  v_permlane16_swap_b32 v50, v106
  v_permlane16_swap_b32 v51, v107
  v_permlane16_swap_b32 v52, v108
  v_permlane16_swap_b32 v53, v109
  v_permlane16_swap_b32 v54, v110
  v_permlane16_swap_b32 v55, v111
  ds_read_b128 v[24:27], v12 offset:16
  s_waitcnt lgkmcnt(0)
  v_min3_u32 v24, v24, v25, v26
  v_min_u32 v24, v24, v27
  v_cmp_gt_u32 vcc, 20, v24
  s_cbranch_vccnz Lspin_66
Lok_65:
  ds_read_b128 v[56:59], v8 offset:49152
  ds_read_b128 v[112:115], v9 offset:49152
  ds_read_b128 v[60:63], v10 offset:49152
  ds_read_b128 v[116:119], v11 offset:49152
  s_waitcnt lgkmcnt(0)
  v_mov_b32 v29, 5
  ds_write_b32 v13, v29
  v_permlane16_swap_b32 v56, v112
  v_permlane16_swap_b32 v57, v113
  v_permlane16_swap_b32 v58, v114
  v_permlane16_swap_b32 v59, v115
  v_permlane16_swap_b32 v60, v116
  v_permlane16_swap_b32 v61, v117
  v_permlane16_swap_b32 v62, v118
  v_permlane16_swap_b32 v63, v119
  ds_read_b128 v[24:27], v12 offset:16
  s_waitcnt lgkmcnt(0)
  v_min3_u32 v24, v24, v25, v26
  v_min_u32 v24, v24, v27
  v_cmp_gt_u32 vcc, 24, v24
  s_cbranch_vccnz Lspin_68
Lok_67:
  ds_read_b128 v[64:67], v8 offset:0
  ds_read_b128 v[120:123], v9 offset:0
  ds_read_b128 v[68:71], v10 offset:0
  ds_read_b128 v[124:127], v11 offset:0
  s_waitcnt lgkmcnt(0)
  v_mov_b32 v29, 6
  ds_write_b32 v13, v29
  v_permlane16_swap_b32 v64, v120
  v_permlane16_swap_b32 v65, v121
  v_permlane16_swap_b32 v66, v122
  v_permlane16_swap_b32 v67, v123
  v_permlane16_swap_b32 v68, v124
  v_permlane16_swap_b32 v69, v125
  v_permlane16_swap_b32 v70, v126
  v_permlane16_swap_b32 v71, v127
  ds_read_b128 v[24:27], v12 offset:16
  s_waitcnt lgkmcnt(0)
  v_min3_u32 v24, v24, v25, v26
  v_min_u32 v24, v24, v27
  v_cmp_gt_u32 vcc, 28, v24
  s_cbranch_vccnz Lspin_70
Lok_69:
  ds_read_b128 v[72:75], v8 offset:16384
  ds_read_b128 v[128:131], v9 offset:16384
  ds_read_b128 v[76:79], v10 offset:16384
  ds_read_b128 v[132:135], v11 offset:16384
  s_waitcnt lgkmcnt(0)
  v_mov_b32 v29, 7
  ds_write_b32 v13, v29
  v_permlane16_swap_b32 v72, v128
  v_permlane16_swap_b32 v73, v129
  v_permlane16_swap_b32 v74, v130
  v_permlane16_swap_b32 v75, v131
  v_permlane16_swap_b32 v76, v132
  v_permlane16_swap_b32 v77, v133
  v_permlane16_swap_b32 v78, v134
  v_permlane16_swap_b32 v79, v135
  ds_read_b128 v[24:27], v12 offset:16
  s_waitcnt lgkmcnt(0)
  v_min3_u32 v24, v24, v25, v26
  v_min_u32 v24, v24, v27
  v_cmp_gt_u32 vcc, 32, v24
  s_cbranch_vccnz Lspin_72
Lok_71:
  ds_read_b128 v[80:83], v8 offset:32768
  ds_read_b128 v[136:139], v9 offset:32768
  ds_read_b128 v[84:87], v10 offset:32768
  ds_read_b128 v[140:143], v11 offset:32768
  s_waitcnt lgkmcnt(0)
  v_mov_b32 v29, 8
  ds_write_b32 v13, v29
  v_permlane16_swap_b32 v80, v136
  v_permlane16_swap_b32 v81, v137
  v_permlane16_swap_b32 v82, v138
  v_permlane16_swap_b32 v83, v139
  v_permlane16_swap_b32 v84, v140
  v_permlane16_swap_b32 v85, v141
  v_permlane16_swap_b32 v86, v142
  v_permlane16_swap_b32 v87, v143
  v_mov_b32 v29, 16
  ds_write_b32 v13, v29
  v_mov_b32 v28, s67
  s_mov_b32 s7, 1
  s_mov_b32 s6, 0
L_p1_b:
  s_waitcnt lgkmcnt(0)
  v_add_u32 v16, 0, v14
  v_add_u32 v19, 0, v30
  v_add_u32 v253, 0, v31
  v_add_u32 v17, 65536, v14
  v_add_u32 v20, 65536, v30
  v_add_u32 v254, 65536, v31
  v_add_u32 v18, 122880, v14
  v_add_u32 v21, 122880, v30
  v_add_u32 v255, 122880, v31
  ds_read_b128 v[24:27], v12 offset:16
  s_waitcnt lgkmcnt(0)
  v_min3_u32 v24, v24, v25, v26
  v_min_u32 v24, v24, v27
  v_cmp_gt_u32 vcc, 65, v24
  s_cbranch_vccnz Lspin_74
Lok_73:
  ds_read_b128 v[196:199], v17 offset:0
  ds_read_b128 v[200:203], v17 offset:1024
  ds_read_b128 v[204:207], v17 offset:2048
  ds_read_b128 v[208:211], v17 offset:3072
  ds_read_b128 v[212:215], v17 offset:4096
  ds_read_b128 v[216:219], v17 offset:5120
  ds_read_b128 v[220:223], v20 offset:0
  s_waitcnt lgkmcnt(6)
  v_mfma_f32_16x16x32_bf16 v[144:147], v[196:199], v[32:35], 0
  v_mfma_f32_16x16x32_bf16 v[168:171], v[196:199], v[88:91], 0
  s_getreg_b32 s3, hwreg(HW_REG_IB_STS)
  s_and_b32 s3, s3, 0x00c0000f
  s_or_b32 s3, s3, s7
  s_cbranch_scc1 Ltf_87
  s_mov_b64 exec, 1
  buffer_store_dword v28, v15, s[32:35], s6 offen sc1
  s_mov_b64 exec, -1
  s_mov_b32 s7, 1
Ltf_87:
  ds_read_b128 v[224:227], v254 offset:0
  s_waitcnt lgkmcnt(6)
  v_mfma_f32_16x16x32_bf16 v[148:151], v[200:203], v[32:35], 0
  v_mfma_f32_16x16x32_bf16 v[172:175], v[200:203], v[88:91], 0
  ds_read_b128 v[228:231], v17 offset:7168
  s_waitcnt lgkmcnt(6)
  v_mfma_f32_16x16x32_bf16 v[152:155], v[204:207], v[32:35], 0
  v_mfma_f32_16x16x32_bf16 v[176:179], v[204:207], v[88:91], 0
  ds_read_b128 v[24:27], v12 offset:16
  ds_read_b128 v[232:235], v17 offset:8192
  s_waitcnt lgkmcnt(7)
  v_mfma_f32_16x16x32_bf16 v[156:159], v[208:211], v[32:35], 0
  v_mfma_f32_16x16x32_bf16 v[180:183], v[208:211], v[88:91], 0
  ds_read_b128 v[196:199], v17 offset:9216
  s_waitcnt lgkmcnt(7)
  v_mfma_f32_16x16x32_bf16 v[160:163], v[32:35], v[212:215], 0
  v_mfma_f32_16x16x32_bf16 v[184:187], v[88:91], v[212:215], 0
  ds_read_b128 v[200:203], v17 offset:10240
  s_waitcnt lgkmcnt(7)
  v_mfma_f32_16x16x32_bf16 v[164:167], v[32:35], v[216:219], 0
  v_mfma_f32_16x16x32_bf16 v[188:191], v[88:91], v[216:219], 0
  ds_read_b128 v[204:207], v17 offset:11264
  s_waitcnt lgkmcnt(4)
  v_min3_u32 v24, v24, v25, v26
  ds_read_b128 v[208:211], v17 offset:12288
  v_mfma_f32_16x16x32_bf16 v[192:195], v[220:223], v[224:227], 0
  v_min_u32 v24, v24, v27
  ds_read_b128 v[212:215], v20 offset:7168
  v_mfma_f32_16x16x32_bf16 v[144:147], v[228:231], v[36:39], v[144:147]
  v_mfma_f32_16x16x32_bf16 v[168:171], v[228:231], v[92:95], v[168:171]
  v_cmp_gt_u32 vcc, 69, v24
  s_getreg_b32 s3, hwreg(HW_REG_IB_STS)
  s_and_b32 s3, s3, 0x00c0000f
  s_or_b32 s3, s3, s7
  s_cbranch_scc1 Ltf_88
  s_mov_b64 exec, 1
  buffer_store_dword v28, v15, s[32:35], s6 offen sc1
  s_mov_b64 exec, -1
  s_mov_b32 s7, 1
Ltf_88:
  ds_read_b128 v[216:219], v254 offset:7168
  s_waitcnt lgkmcnt(6)
  v_mfma_f32_16x16x32_bf16 v[148:151], v[232:235], v[36:39], v[148:151]
  v_mfma_f32_16x16x32_bf16 v[172:175], v[232:235], v[92:95], v[172:175]
  s_cbranch_vccnz Lspin_76
Lok_75:
  ds_read_b128 v[220:223], v17 offset:14336
  s_waitcnt lgkmcnt(6)
  v_mfma_f32_16x16x32_bf16 v[152:155], v[196:199], v[36:39], v[152:155]
  v_mfma_f32_16x16x32_bf16 v[176:179], v[196:199], v[92:95], v[176:179]
  ds_read_b128 v[224:227], v17 offset:15360
  s_waitcnt lgkmcnt(6)
  v_mfma_f32_16x16x32_bf16 v[156:159], v[200:203], v[36:39], v[156:159]
  v_mfma_f32_16x16x32_bf16 v[180:183], v[200:203], v[92:95], v[180:183]
  ds_read_b128 v[228:231], v17 offset:16384
  s_waitcnt lgkmcnt(6)
  v_mfma_f32_16x16x32_bf16 v[160:163], v[36:39], v[204:207], v[160:163]
  v_mfma_f32_16x16x32_bf16 v[184:187], v[92:95], v[204:207], v[184:187]
  ds_read_b128 v[232:235], v17 offset:17408
  s_waitcnt lgkmcnt(6)
  v_mfma_f32_16x16x32_bf16 v[164:167], v[36:39], v[208:211], v[164:167]
  v_mfma_f32_16x16x32_bf16 v[188:191], v[92:95], v[208:211], v[188:191]
  ds_read_b128 v[196:199], v17 offset:18432
  ds_read_b128 v[200:203], v17 offset:19456
  s_waitcnt lgkmcnt(6)
  v_mfma_f32_16x16x32_bf16 v[192:195], v[212:215], v[216:219], v[192:195]
  ds_read_b128 v[204:207], v20 offset:14336
  s_waitcnt lgkmcnt(6)
  v_mfma_f32_16x16x32_bf16 v[144:147], v[220:223], v[40:43], v[144:147]
  v_mfma_f32_16x16x32_bf16 v[168:171], v[220:223], v[96:99], v[168:171]
  s_getreg_b32 s3, hwreg(HW_REG_IB_STS)
  s_and_b32 s3, s3, 0x00c0000f
  s_or_b32 s3, s3, s7
  s_cbranch_scc1 Ltf_89
  s_mov_b64 exec, 1
  buffer_store_dword v28, v15, s[32:35], s6 offen sc1
  s_mov_b64 exec, -1
  s_mov_b32 s7, 1
Ltf_89:
  ds_read_b128 v[208:211], v254 offset:14336
  s_waitcnt lgkmcnt(6)
  v_mfma_f32_16x16x32_bf16 v[148:151], v[224:227], v[40:43], v[148:151]
  v_mfma_f32_16x16x32_bf16 v[172:175], v[224:227], v[96:99], v[172:175]
  ds_read_b128 v[212:215], v17 offset:21504
  s_waitcnt lgkmcnt(6)
  v_mfma_f32_16x16x32_bf16 v[152:155], v[228:231], v[40:43], v[152:155]
  v_mfma_f32_16x16x32_bf16 v[176:179], v[228:231], v[96:99], v[176:179]
  ds_read_b128 v[24:27], v12 offset:16
  ds_read_b128 v[216:219], v17 offset:22528
  s_waitcnt lgkmcnt(7)
  v_mfma_f32_16x16x32_bf16 v[156:159], v[232:235], v[40:43], v[156:159]
  v_mfma_f32_16x16x32_bf16 v[180:183], v[232:235], v[96:99], v[180:183]
  ds_read_b128 v[220:223], v17 offset:23552
  s_waitcnt lgkmcnt(7)
  v_mfma_f32_16x16x32_bf16 v[160:163], v[40:43], v[196:199], v[160:163]
  v_mfma_f32_16x16x32_bf16 v[184:187], v[96:99], v[196:199], v[184:187]
  ds_read_b128 v[224:227], v17 offset:24576
  s_waitcnt lgkmcnt(7)
  v_mfma_f32_16x16x32_bf16 v[164:167], v[40:43], v[200:203], v[164:167]
  v_mfma_f32_16x16x32_bf16 v[188:191], v[96:99], v[200:203], v[188:191]
  ds_read_b128 v[228:231], v17 offset:25600
  s_waitcnt lgkmcnt(4)
  v_min3_u32 v24, v24, v25, v26
  ds_read_b128 v[232:235], v17 offset:26624
  v_mfma_f32_16x16x32_bf16 v[192:195], v[204:207], v[208:211], v[192:195]
  v_min_u32 v24, v24, v27
  ds_read_b128 v[196:199], v20 offset:21504
  v_mfma_f32_16x16x32_bf16 v[144:147], v[212:215], v[44:47], v[144:147]
  v_mfma_f32_16x16x32_bf16 v[168:171], v[212:215], v[100:103], v[168:171]
  v_cmp_gt_u32 vcc, 73, v24
  s_getreg_b32 s3, hwreg(HW_REG_IB_STS)
  s_and_b32 s3, s3, 0x00c0000f
  s_or_b32 s3, s3, s7
  s_cbranch_scc1 Ltf_90
  s_mov_b64 exec, 1
  buffer_store_dword v28, v15, s[32:35], s6 offen sc1
  s_mov_b64 exec, -1
  s_mov_b32 s7, 1
Ltf_90:
  ds_read_b128 v[200:203], v254 offset:21504
  s_waitcnt lgkmcnt(6)
  v_mfma_f32_16x16x32_bf16 v[148:151], v[216:219], v[44:47], v[148:151]
  v_mfma_f32_16x16x32_bf16 v[172:175], v[216:219], v[100:103], v[172:175]
  s_cbranch_vccnz Lspin_78
Lok_77:
  ds_read_b128 v[204:207], v17 offset:28672
  s_waitcnt lgkmcnt(6)
  v_mfma_f32_16x16x32_bf16 v[152:155], v[220:223], v[44:47], v[152:155]
  v_mfma_f32_16x16x32_bf16 v[176:179], v[220:223], v[100:103], v[176:179]
  ds_read_b128 v[208:211], v17 offset:29696
  s_waitcnt lgkmcnt(6)
  v_mfma_f32_16x16x32_bf16 v[156:159], v[224:227], v[44:47], v[156:159]
  v_mfma_f32_16x16x32_bf16 v[180:183], v[224:227], v[100:103], v[180:183]
  ds_read_b128 v[212:215], v17 offset:30720
  s_waitcnt lgkmcnt(6)
  v_mfma_f32_16x16x32_bf16 v[160:163], v[44:47], v[228:231], v[160:163]
  v_mfma_f32_16x16x32_bf16 v[184:187], v[100:103], v[228:231], v[184:187]
  ds_read_b128 v[216:219], v17 offset:31744
  s_waitcnt lgkmcnt(6)
  v_mfma_f32_16x16x32_bf16 v[164:167], v[44:47], v[232:235], v[164:167]
  v_mfma_f32_16x16x32_bf16 v[188:191], v[100:103], v[232:235], v[188:191]
  ds_read_b128 v[220:223], v17 offset:32768
  ds_read_b128 v[224:227], v17 offset:33792
  s_waitcnt lgkmcnt(6)
  v_mfma_f32_16x16x32_bf16 v[192:195], v[196:199], v[200:203], v[192:195]
  ds_read_b128 v[228:231], v20 offset:28672
  s_waitcnt lgkmcnt(6)
  v_mfma_f32_16x16x32_bf16 v[144:147], v[204:207], v[48:51], v[144:147]
  v_mfma_f32_16x16x32_bf16 v[168:171], v[204:207], v[104:107], v[168:171]
  s_getreg_b32 s3, hwreg(HW_REG_IB_STS)
  s_and_b32 s3, s3, 0x00c0000f
  s_or_b32 s3, s3, s7
  s_cbranch_scc1 Ltf_91
  s_mov_b64 exec, 1
  buffer_store_dword v28, v15, s[32:35], s6 offen sc1
  s_mov_b64 exec, -1
  s_mov_b32 s7, 1
Ltf_91:
  ds_read_b128 v[232:235], v254 offset:28672
  s_waitcnt lgkmcnt(6)
  v_mfma_f32_16x16x32_bf16 v[148:151], v[208:211], v[48:51], v[148:151]
  v_mfma_f32_16x16x32_bf16 v[172:175], v[208:211], v[104:107], v[172:175]
  ds_read_b128 v[196:199], v17 offset:35840
  s_waitcnt lgkmcnt(6)
  v_mfma_f32_16x16x32_bf16 v[152:155], v[212:215], v[48:51], v[152:155]
  v_mfma_f32_16x16x32_bf16 v[176:179], v[212:215], v[104:107], v[176:179]
  ds_read_b128 v[24:27], v12 offset:16
  ds_read_b128 v[200:203], v17 offset:36864
  s_waitcnt lgkmcnt(7)
  v_mfma_f32_16x16x32_bf16 v[156:159], v[216:219], v[48:51], v[156:159]
  v_mfma_f32_16x16x32_bf16 v[180:183], v[216:219], v[104:107], v[180:183]
  ds_read_b128 v[204:207], v17 offset:37888
  s_waitcnt lgkmcnt(7)
  v_mfma_f32_16x16x32_bf16 v[160:163], v[48:51], v[220:223], v[160:163]
  v_mfma_f32_16x16x32_bf16 v[184:187], v[104:107], v[220:223], v[184:187]
  ds_read_b128 v[208:211], v17 offset:38912
  s_waitcnt lgkmcnt(7)
  v_mfma_f32_16x16x32_bf16 v[164:167], v[48:51], v[224:227], v[164:167]
  v_mfma_f32_16x16x32_bf16 v[188:191], v[104:107], v[224:227], v[188:191]
  ds_read_b128 v[212:215], v17 offset:39936
  s_waitcnt lgkmcnt(4)
  v_min3_u32 v24, v24, v25, v26
  ds_read_b128 v[216:219], v17 offset:40960
  v_mfma_f32_16x16x32_bf16 v[192:195], v[228:231], v[232:235], v[192:195]
  v_min_u32 v24, v24, v27
  ds_read_b128 v[220:223], v20 offset:35840
  v_mfma_f32_16x16x32_bf16 v[144:147], v[196:199], v[52:55], v[144:147]
  v_mfma_f32_16x16x32_bf16 v[168:171], v[196:199], v[108:111], v[168:171]
  v_cmp_gt_u32 vcc, 77, v24
  s_getreg_b32 s3, hwreg(HW_REG_IB_STS)
  s_and_b32 s3, s3, 0x00c0000f
  s_or_b32 s3, s3, s7
  s_cbranch_scc1 Ltf_92
  s_mov_b64 exec, 1
  buffer_store_dword v28, v15, s[32:35], s6 offen sc1
  s_mov_b64 exec, -1
  s_mov_b32 s7, 1
Ltf_92:
  ds_read_b128 v[224:227], v254 offset:35840
  s_waitcnt lgkmcnt(6)
  v_mfma_f32_16x16x32_bf16 v[148:151], v[200:203], v[52:55], v[148:151]
  v_mfma_f32_16x16x32_bf16 v[172:175], v[200:203], v[108:111], v[172:175]
  s_cbranch_vccnz Lspin_80
Lok_79:
  ds_read_b128 v[228:231], v17 offset:43008
  s_waitcnt lgkmcnt(6)
  v_mfma_f32_16x16x32_bf16 v[152:155], v[204:207], v[52:55], v[152:155]
  v_mfma_f32_16x16x32_bf16 v[176:179], v[204:207], v[108:111], v[176:179]
  ds_read_b128 v[232:235], v17 offset:44032
  s_waitcnt lgkmcnt(6)
  v_mfma_f32_16x16x32_bf16 v[156:159], v[208:211], v[52:55], v[156:159]
  v_mfma_f32_16x16x32_bf16 v[180:183], v[208:211], v[108:111], v[180:183]
  ds_read_b128 v[196:199], v17 offset:45056
  s_waitcnt lgkmcnt(6)
  v_mfma_f32_16x16x32_bf16 v[160:163], v[52:55], v[212:215], v[160:163]
  v_mfma_f32_16x16x32_bf16 v[184:187], v[108:111], v[212:215], v[184:187]
  ds_read_b128 v[200:203], v17 offset:46080
  s_waitcnt lgkmcnt(6)
  v_mfma_f32_16x16x32_bf16 v[164:167], v[52:55], v[216:219], v[164:167]
  v_mfma_f32_16x16x32_bf16 v[188:191], v[108:111], v[216:219], v[188:191]
  ds_read_b128 v[204:207], v17 offset:47104
  ds_read_b128 v[208:211], v17 offset:48128
  s_waitcnt lgkmcnt(6)
  v_mfma_f32_16x16x32_bf16 v[192:195], v[220:223], v[224:227], v[192:195]
  ds_read_b128 v[212:215], v20 offset:43008
  s_waitcnt lgkmcnt(6)
  v_mfma_f32_16x16x32_bf16 v[144:147], v[228:231], v[56:59], v[144:147]
  v_mfma_f32_16x16x32_bf16 v[168:171], v[228:231], v[112:115], v[168:171]
  s_getreg_b32 s3, hwreg(HW_REG_IB_STS)
  s_and_b32 s3, s3, 0x00c0000f
  s_or_b32 s3, s3, s7
  s_cbranch_scc1 Ltf_93
  s_mov_b64 exec, 1
  buffer_store_dword v28, v15, s[32:35], s6 offen sc1
  s_mov_b64 exec, -1
  s_mov_b32 s7, 1
Ltf_93:
  ds_read_b128 v[216:219], v254 offset:43008
  s_waitcnt lgkmcnt(6)
  v_mfma_f32_16x16x32_bf16 v[148:151], v[232:235], v[56:59], v[148:151]
  v_mfma_f32_16x16x32_bf16 v[172:175], v[232:235], v[112:115], v[172:175]
  ds_read_b128 v[220:223], v17 offset:50176
  s_waitcnt lgkmcnt(6)
  v_mfma_f32_16x16x32_bf16 v[152:155], v[196:199], v[56:59], v[152:155]
  v_mfma_f32_16x16x32_bf16 v[176:179], v[196:199], v[112:115], v[176:179]
  ds_read_b128 v[24:27], v12 offset:16
  ds_read_b128 v[224:227], v17 offset:51200
  s_waitcnt lgkmcnt(7)
  v_mfma_f32_16x16x32_bf16 v[156:159], v[200:203], v[56:59], v[156:159]
  v_mfma_f32_16x16x32_bf16 v[180:183], v[200:203], v[112:115], v[180:183]
  ds_read_b128 v[228:231], v17 offset:52224
  s_waitcnt lgkmcnt(7)
  v_mfma_f32_16x16x32_bf16 v[160:163], v[56:59], v[204:207], v[160:163]
  v_mfma_f32_16x16x32_bf16 v[184:187], v[112:115], v[204:207], v[184:187]
  ds_read_b128 v[232:235], v17 offset:53248
  s_waitcnt lgkmcnt(7)
  v_mfma_f32_16x16x32_bf16 v[164:167], v[56:59], v[208:211], v[164:167]
  v_mfma_f32_16x16x32_bf16 v[188:191], v[112:115], v[208:211], v[188:191]
  ds_read_b128 v[196:199], v17 offset:54272
  s_waitcnt lgkmcnt(4)
  v_min3_u32 v24, v24, v25, v26
  ds_read_b128 v[200:203], v17 offset:55296
  v_mfma_f32_16x16x32_bf16 v[192:195], v[212:215], v[216:219], v[192:195]
  v_min_u32 v24, v24, v27
  ds_read_b128 v[204:207], v20 offset:50176
  v_mfma_f32_16x16x32_bf16 v[144:147], v[220:223], v[60:63], v[144:147]
  v_mfma_f32_16x16x32_bf16 v[168:171], v[220:223], v[116:119], v[168:171]
  v_cmp_gt_u32 vcc, 81, v24
  s_getreg_b32 s3, hwreg(HW_REG_IB_STS)
  s_and_b32 s3, s3, 0x00c0000f
  s_or_b32 s3, s3, s7
  s_cbranch_scc1 Ltf_94
  s_mov_b64 exec, 1
  buffer_store_dword v28, v15, s[32:35], s6 offen sc1
  s_mov_b64 exec, -1
  s_mov_b32 s7, 1
Ltf_94:
  ds_read_b128 v[208:211], v254 offset:50176
  s_waitcnt lgkmcnt(6)
  v_mfma_f32_16x16x32_bf16 v[148:151], v[224:227], v[60:63], v[148:151]
  v_mfma_f32_16x16x32_bf16 v[172:175], v[224:227], v[116:119], v[172:175]
  s_cbranch_vccnz Lspin_82
Lok_81:
  ds_read_b128 v[212:215], v16 offset:16384
  s_waitcnt lgkmcnt(6)
  v_mfma_f32_16x16x32_bf16 v[152:155], v[228:231], v[60:63], v[152:155]
  v_mfma_f32_16x16x32_bf16 v[176:179], v[228:231], v[116:119], v[176:179]
  ds_read_b128 v[216:219], v16 offset:17408
  s_waitcnt lgkmcnt(6)
  v_mfma_f32_16x16x32_bf16 v[156:159], v[232:235], v[60:63], v[156:159]
  v_mfma_f32_16x16x32_bf16 v[180:183], v[232:235], v[116:119], v[180:183]
  ds_read_b128 v[220:223], v16 offset:18432
  s_waitcnt lgkmcnt(6)
  v_mfma_f32_16x16x32_bf16 v[160:163], v[60:63], v[196:199], v[160:163]
  v_mfma_f32_16x16x32_bf16 v[184:187], v[116:119], v[196:199], v[184:187]
  ds_read_b128 v[224:227], v16 offset:19456
  s_waitcnt lgkmcnt(6)
  v_mfma_f32_16x16x32_bf16 v[164:167], v[60:63], v[200:203], v[164:167]
  v_mfma_f32_16x16x32_bf16 v[188:191], v[116:119], v[200:203], v[188:191]
  ds_read_b128 v[228:231], v16 offset:20480
  ds_read_b128 v[232:235], v16 offset:21504
  s_waitcnt lgkmcnt(6)
  v_mfma_f32_16x16x32_bf16 v[192:195], v[204:207], v[208:211], v[192:195]
  ds_read_b128 v[196:199], v19 offset:16384
  s_waitcnt lgkmcnt(6)
  v_mfma_f32_16x16x32_bf16 v[144:147], v[212:215], v[64:67], v[144:147]
  v_mfma_f32_16x16x32_bf16 v[168:171], v[212:215], v[120:123], v[168:171]
  ds_read_b128 v[200:203], v253 offset:16384
  s_waitcnt lgkmcnt(6)
  v_mfma_f32_16x16x32_bf16 v[148:151], v[216:219], v[64:67], v[148:151]
  v_mfma_f32_16x16x32_bf16 v[172:175], v[216:219], v[120:123], v[172:175]
  v_mov_b32 v248, 0xf149f2ca
  ds_read_b128 v[204:207], v16 offset:23552
  s_waitcnt lgkmcnt(6)
  v_mfma_f32_16x16x32_bf16 v[152:155], v[220:223], v[64:67], v[152:155]
  v_mfma_f32_16x16x32_bf16 v[176:179], v[220:223], v[120:123], v[176:179]
  ds_read_b128 v[24:27], v12 offset:16
  ds_read_b128 v[208:211], v16 offset:24576
  s_waitcnt lgkmcnt(7)
  v_mfma_f32_16x16x32_bf16 v[156:159], v[224:227], v[64:67], v[156:159]
  v_mfma_f32_16x16x32_bf16 v[180:183], v[224:227], v[120:123], v[180:183]
  s_mov_b32 s60, 0x55505555
  s_mov_b32 s61, 0x50005500
  v_cndmask_b32 v236, v248, 0, s[60:61]
  ds_read_b128 v[212:215], v16 offset:25600
  s_waitcnt lgkmcnt(7)
  v_mfma_f32_16x16x32_bf16 v[160:163], v[64:67], v[228:231], v[160:163]
  v_mfma_f32_16x16x32_bf16 v[184:187], v[120:123], v[228:231], v[184:187]
  ds_read_b128 v[216:219], v16 offset:26624
  s_waitcnt lgkmcnt(7)
  v_mfma_f32_16x16x32_bf16 v[164:167], v[64:67], v[232:235], v[164:167]
  v_mfma_f32_16x16x32_bf16 v[188:191], v[120:123], v[232:235], v[188:191]
  s_mov_b32 s60, 0x00050000
  s_mov_b32 s61, 0x05550055
  v_cndmask_b32 v240, v248, 0, s[60:61]
  ds_read_b128 v[220:223], v16 offset:27648
  s_waitcnt lgkmcnt(4)
  v_min3_u32 v24, v24, v25, v26
  ds_read_b128 v[224:227], v16 offset:28672
  v_mfma_f32_16x16x32_bf16 v[192:195], v[196:199], v[200:203], v[192:195]
  s_mov_b32 s60, 0xaaa0aaaa
  s_mov_b32 s61, 0xa000aa00
  v_cndmask_b32 v237, v248, 0, s[60:61]
  v_min_u32 v24, v24, v27
  ds_read_b128 v[228:231], v19 offset:23552
  v_mfma_f32_16x16x32_bf16 v[144:147], v[204:207], v[68:71], v[144:147]
  v_mfma_f32_16x16x32_bf16 v[168:171], v[204:207], v[124:127], v[168:171]
  v_cmp_gt_u32 vcc, 86, v24
  ds_read_b128 v[232:235], v253 offset:23552
  s_waitcnt lgkmcnt(6)
  v_mfma_f32_16x16x32_bf16 v[148:151], v[208:211], v[68:71], v[148:151]
  v_mfma_f32_16x16x32_bf16 v[172:175], v[208:211], v[124:127], v[172:175]
  s_mov_b32 s60, 0x000a0000
  s_mov_b32 s61, 0x0aaa00aa
  v_cndmask_b32 v241, v248, 0, s[60:61]
  s_cbranch_vccnz Lspin_84
Lok_83:
  ds_read_b128 v[196:199], v16 offset:30720
  s_waitcnt lgkmcnt(6)
  v_mfma_f32_16x16x32_bf16 v[152:155], v[212:215], v[68:71], v[152:155]
  v_mfma_f32_16x16x32_bf16 v[176:179], v[212:215], v[124:127], v[176:179]
  ds_read_b128 v[200:203], v16 offset:31744
  s_waitcnt lgkmcnt(6)
  v_mfma_f32_16x16x32_bf16 v[156:159], v[216:219], v[68:71], v[156:159]
  v_mfma_f32_16x16x32_bf16 v[180:183], v[216:219], v[124:127], v[180:183]
  s_mov_b32 s60, 0x55405554
  s_mov_b32 s61, 0x40005400
  v_cndmask_b32 v238, v248, 0, s[60:61]
  ds_read_b128 v[204:207], v16 offset:32768
  s_waitcnt lgkmcnt(6)
  v_mfma_f32_16x16x32_bf16 v[160:163], v[68:71], v[220:223], v[160:163]
  v_mfma_f32_16x16x32_bf16 v[184:187], v[124:127], v[220:223], v[184:187]
  ds_read_b128 v[208:211], v16 offset:33792
  s_waitcnt lgkmcnt(6)
  v_mfma_f32_16x16x32_bf16 v[164:167], v[68:71], v[224:227], v[164:167]
  v_mfma_f32_16x16x32_bf16 v[188:191], v[124:127], v[224:227], v[188:191]
  s_mov_b32 s60, 0x00150001
  s_mov_b32 s61, 0x15550155
  v_cndmask_b32 v242, v248, 0, s[60:61]
  ds_read_b128 v[212:215], v16 offset:34816
  ds_read_b128 v[216:219], v16 offset:35840
  s_waitcnt lgkmcnt(6)
  v_mfma_f32_16x16x32_bf16 v[192:195], v[228:231], v[232:235], v[192:195]
  s_mov_b32 s60, 0xaa80aaa8
  s_mov_b32 s61, 0x8000a800
  v_cndmask_b32 v239, v248, 0, s[60:61]
  ds_read_b128 v[220:223], v19 offset:30720
  s_waitcnt lgkmcnt(6)
  v_mfma_f32_16x16x32_bf16 v[144:147], v[196:199], v[72:75], v[144:147]
  v_mfma_f32_16x16x32_bf16 v[168:171], v[196:199], v[128:131], v[168:171]
  ds_read_b128 v[224:227], v253 offset:30720
  s_waitcnt lgkmcnt(6)
  v_mfma_f32_16x16x32_bf16 v[148:151], v[200:203], v[72:75], v[148:151]
  v_mfma_f32_16x16x32_bf16 v[172:175], v[200:203], v[128:131], v[172:175]
  s_mov_b32 s60, 0x002a0002
  s_mov_b32 s61, 0x2aaa02aa
  v_cndmask_b32 v243, v248, 0, s[60:61]
  ds_read_b128 v[228:231], v16 offset:37888
  s_waitcnt lgkmcnt(6)
  v_mfma_f32_16x16x32_bf16 v[152:155], v[204:207], v[72:75], v[152:155]
  v_mfma_f32_16x16x32_bf16 v[176:179], v[204:207], v[128:131], v[176:179]
  ds_read_b128 v[24:27], v12 offset:16
  ds_read_b128 v[232:235], v16 offset:38912
  s_waitcnt lgkmcnt(7)
  v_mfma_f32_16x16x32_bf16 v[156:159], v[208:211], v[72:75], v[156:159]
  v_mfma_f32_16x16x32_bf16 v[180:183], v[208:211], v[128:131], v[180:183]
  s_or_b32 s63, s55, s68
  s_cselect_b64 s[60:61], 0, -1
  v_cndmask_b32 v244, v240, v248, s[60:61]
  v_cndmask_b32 v245, v241, v248, s[60:61]
  v_cndmask_b32 v246, v242, v248, s[60:61]
  v_cndmask_b32 v247, v243, v248, s[60:61]
  ds_read_b128 v[196:199], v16 offset:39936
  s_waitcnt lgkmcnt(7)
  v_mfma_f32_16x16x32_bf16 v[160:163], v[72:75], v[212:215], v[160:163]
  v_mfma_f32_16x16x32_bf16 v[184:187], v[128:131], v[212:215], v[184:187]
  ds_read_b128 v[200:203], v16 offset:40960
  s_waitcnt lgkmcnt(7)
  v_mfma_f32_16x16x32_bf16 v[164:167], v[72:75], v[216:219], v[164:167]
  v_mfma_f32_16x16x32_bf16 v[188:191], v[128:131], v[216:219], v[188:191]
  ds_read_b128 v[204:207], v16 offset:41984
  s_waitcnt lgkmcnt(4)
  v_min3_u32 v24, v24, v25, v26
  ds_read_b128 v[208:211], v16 offset:43008
  v_mfma_f32_16x16x32_bf16 v[192:195], v[220:223], v[224:227], v[192:195]
  v_min_u32 v24, v24, v27
  ds_read_b128 v[212:215], v19 offset:37888
  v_mfma_f32_16x16x32_bf16 v[144:147], v[228:231], v[76:79], v[144:147]
  v_mfma_f32_16x16x32_bf16 v[168:171], v[228:231], v[132:135], v[168:171]
  v_cmp_gt_u32 vcc, 90, v24
  ds_read_b128 v[216:219], v253 offset:37888
  s_waitcnt lgkmcnt(6)
  v_mfma_f32_16x16x32_bf16 v[148:151], v[232:235], v[76:79], v[148:151]
  v_mfma_f32_16x16x32_bf16 v[172:175], v[232:235], v[132:135], v[172:175]
  s_cbranch_vccnz Lspin_86
Lok_85:
  ds_read_b128 v[220:223], v18 offset:0
  s_waitcnt lgkmcnt(6)
  v_mfma_f32_16x16x32_bf16 v[152:155], v[196:199], v[76:79], v[152:155]
  v_mfma_f32_16x16x32_bf16 v[176:179], v[196:199], v[132:135], v[176:179]
  ds_read_b128 v[224:227], v18 offset:1024
  s_waitcnt lgkmcnt(6)
  v_mfma_f32_16x16x32_bf16 v[156:159], v[200:203], v[76:79], v[156:159]
  v_mfma_f32_16x16x32_bf16 v[180:183], v[200:203], v[132:135], v[180:183]
  ds_read_b128 v[228:231], v18 offset:2048
  s_waitcnt lgkmcnt(6)
  v_mfma_f32_16x16x32_bf16 v[160:163], v[76:79], v[204:207], v[160:163]
  v_mfma_f32_16x16x32_bf16 v[184:187], v[132:135], v[204:207], v[184:187]
  ds_read_b128 v[232:235], v18 offset:3072
  s_waitcnt lgkmcnt(6)
  v_mfma_f32_16x16x32_bf16 v[164:167], v[76:79], v[208:211], v[164:167]
  v_mfma_f32_16x16x32_bf16 v[188:191], v[132:135], v[208:211], v[188:191]
  ds_read_b128 v[196:199], v18 offset:4096
  ds_read_b128 v[200:203], v18 offset:5120
  s_waitcnt lgkmcnt(6)
  v_mfma_f32_16x16x32_bf16 v[192:195], v[212:215], v[216:219], v[192:195]
  ds_read_b128 v[204:207], v21 offset:0
  s_waitcnt lgkmcnt(6)
  v_mfma_f32_16x16x32_bf16 v[144:147], v[220:223], v[80:83], v[144:147]
  v_mfma_f32_16x16x32_bf16 v[168:171], v[220:223], v[136:139], v[168:171]
  ds_read_b128 v[208:211], v255 offset:0
  s_waitcnt lgkmcnt(6)
  v_mfma_f32_16x16x32_bf16 v[148:151], v[224:227], v[80:83], v[148:151]
  v_mfma_f32_16x16x32_bf16 v[172:175], v[224:227], v[136:139], v[172:175]
  ds_read_b128 v[212:215], v18 offset:7168
  s_waitcnt lgkmcnt(6)
  v_mfma_f32_16x16x32_bf16 v[152:155], v[228:231], v[80:83], v[152:155]
  v_mfma_f32_16x16x32_bf16 v[176:179], v[228:231], v[136:139], v[176:179]
  ds_read_b128 v[216:219], v18 offset:8192
  s_waitcnt lgkmcnt(6)
  v_mfma_f32_16x16x32_bf16 v[156:159], v[232:235], v[80:83], v[156:159]
  v_mfma_f32_16x16x32_bf16 v[180:183], v[232:235], v[136:139], v[180:183]
  ds_read_b128 v[220:223], v18 offset:9216
  s_waitcnt lgkmcnt(6)
  v_mfma_f32_16x16x32_bf16 v[160:163], v[80:83], v[196:199], v[160:163]
  v_mfma_f32_16x16x32_bf16 v[184:187], v[136:139], v[196:199], v[184:187]
  ds_read_b128 v[224:227], v18 offset:10240
  s_waitcnt lgkmcnt(6)
  v_mfma_f32_16x16x32_bf16 v[164:167], v[80:83], v[200:203], v[164:167]
  v_mfma_f32_16x16x32_bf16 v[188:191], v[136:139], v[200:203], v[188:191]
  ds_read_b128 v[228:231], v18 offset:11264
  ds_read_b128 v[232:235], v18 offset:12288
  s_waitcnt lgkmcnt(6)
  v_mfma_f32_16x16x32_bf16 v[192:195], v[204:207], v[208:211], v[192:195]
  ds_read_b128 v[196:199], v21 offset:7168
  s_waitcnt lgkmcnt(6)
  v_mfma_f32_16x16x32_bf16 v[144:147], v[212:215], v[84:87], v[144:147]
  v_mfma_f32_16x16x32_bf16 v[168:171], v[212:215], v[140:143], v[168:171]
  ds_read_b128 v[200:203], v255 offset:7168
  s_waitcnt lgkmcnt(6)
  v_mfma_f32_16x16x32_bf16 v[148:151], v[216:219], v[84:87], v[148:151]
  v_mfma_f32_16x16x32_bf16 v[172:175], v[216:219], v[140:143], v[172:175]
  s_waitcnt lgkmcnt(5)
  v_mfma_f32_16x16x32_bf16 v[152:155], v[220:223], v[84:87], v[152:155]
  v_mfma_f32_16x16x32_bf16 v[176:179], v[220:223], v[140:143], v[176:179]
  s_waitcnt lgkmcnt(4)
  v_mfma_f32_16x16x32_bf16 v[156:159], v[224:227], v[84:87], v[156:159]
  v_mfma_f32_16x16x32_bf16 v[180:183], v[224:227], v[140:143], v[180:183]
  s_waitcnt lgkmcnt(3)
  v_mfma_f32_16x16x32_bf16 v[160:163], v[84:87], v[228:231], v[160:163]
  v_mfma_f32_16x16x32_bf16 v[184:187], v[140:143], v[228:231], v[184:187]
  s_waitcnt lgkmcnt(2)
  v_mfma_f32_16x16x32_bf16 v[164:167], v[84:87], v[232:235], v[164:167]
  v_mfma_f32_16x16x32_bf16 v[188:191], v[140:143], v[232:235], v[188:191]
  s_waitcnt lgkmcnt(0)
  v_mfma_f32_16x16x32_bf16 v[192:195], v[196:199], v[200:203], v[192:195]
  ds_read_b128 v[24:27], v12
  s_lshl_b32 s63, s68, 11
  s_add_u32 s63, s63, 49152
  v_add_u32 v3, s63, v14
  v_add_u32 v1, 2048, v3
  s_lshr_b32 s63, s68, 1
  s_lshl_b32 s63, s63, 10
  s_and_b32 s64, s68, 1
  s_lshl_b32 s64, s64, 3
  s_add_u32 s63, s63, s64
  s_add_u32 s63, s63, 49152
  v_add_u32 v2, s63, v14
  v_cvt_pk_bf16_f32 v44, v176, v177
  v_cvt_pk_bf16_f32 v45, v178, v179
  v_cvt_pk_bf16_f32 v46, v180, v181
  v_cvt_pk_bf16_f32 v47, v182, v183
  v_cvt_pk_bf16_f32 v36, v168, v169
  v_cvt_pk_bf16_f32 v37, v170, v171
  v_cvt_pk_bf16_f32 v38, v172, v173
  v_cvt_pk_bf16_f32 v39, v174, v175
  v_cvt_pk_bf16_f32 v40, v152, v153
  v_cvt_pk_bf16_f32 v41, v154, v155
  v_cvt_pk_bf16_f32 v42, v156, v157
  v_cvt_pk_bf16_f32 v43, v158, v159
  v_cvt_pk_bf16_f32 v72, v184, v185
  v_cvt_pk_bf16_f32 v73, v186, v187
  v_cvt_pk_bf16_f32 v74, v188, v189
  v_cvt_pk_bf16_f32 v75, v190, v191
  v_cvt_pk_bf16_f32 v68, v192, v193
  v_cvt_pk_bf16_f32 v69, v194, v195
  s_waitcnt lgkmcnt(0)
  v_min3_u32 v24, v24, v25, v26
  v_min_u32 v24, v24, v27
  v_cmp_gt_u32 vcc, 16, v24
  s_cbranch_vccnz Lspin_96
Lok_95:
  ds_write_b128 v1, v[44:47]
  ds_write_b128 v1, v[72:75] offset:1024
  ds_write_b64 v2, v[68:69]
  v_mfma_f32_16x16x32_bf16 v[80:83], v[44:47], v[36:39], v[236:239]
  v_mfma_f32_16x16x32_bf16 v[88:91], v[40:43], v[36:39], v[240:243]
  v_cvt_pk_bf16_f32 v32, v144, v145
  v_cvt_pk_bf16_f32 v33, v146, v147
  v_cvt_pk_bf16_f32 v34, v148, v149
  v_cvt_pk_bf16_f32 v35, v150, v151
  s_waitcnt lgkmcnt(0)
  v_mov_b32 v29, 17
  ds_write_b32 v13, v29
  v_mfma_f32_16x16x32_bf16 v[76:79], v[40:43], v[32:35], v[236:239]
  v_cvt_pk_bf16_f32 v54, v160, v161
  v_cvt_pk_bf16_f32 v55, v162, v163
  v_mov_b32 v56, v72
  v_mov_b32 v57, v73
  v_cvt_pk_bf16_f32 v60, v164, v165
  v_cvt_pk_bf16_f32 v61, v166, v167
  v_mov_b32 v62, v74
  v_mov_b32 v63, v75
  v_mov_b32 v124, v148
  v_mov_b32 v128, v172
  v_mov_b32 v125, v148
  v_mov_b32 v129, v172
  s_nop 0
  s_nop 0
  v_permlane32_swap_b32 v124, v125
  v_permlane32_swap_b32 v128, v129
  v_mov_b32 v124, v125
  v_mov_b32 v128, v129
  s_nop 0
  s_nop 0
  v_permlane16_swap_b32 v124, v125
  v_permlane16_swap_b32 v128, v129
  v_mul_f32 v125, 0xbfb8aa3b, v125
  v_mul_f32 v129, 0xbfb8aa3b, v129
  v_exp_f32 v125, v125
  v_exp_f32 v129, v129
  v_add_f32 v125, 1.0, v125
  v_add_f32 v129, 1.0, v129
  v_rcp_f32 v132, v125
  v_rcp_f32 v133, v129
  v_sub_f32 v134, 1.0, v132
  v_sub_f32 v135, 1.0, v133
  s_mul_i32 s64, s57, 72
  s_add_u32 s64, s64, s56
  s_add_u32 s64, s64, 56
  s_lshl_b32 s64, s64, 12
  s_and_b32 s60, s68, 1
  s_lshl_b32 s61, s60, 11
  s_add_u32 s64, s64, s61
  s_lshl_b32 s61, s56, 5
  s_add_u32 s61, s61, s57
  s_lshl_b32 s61, s61, 8
  s_lshl_b32 s60, s60, 3
  s_add_u32 s61, s61, s60
  s_add_u32 s61, s61, 12877824
  s_cmp_lg_u32 s7, 0
  s_cbranch_scc1 Lff_97
  s_waitcnt vmcnt(0)
  s_mov_b64 exec, 1
  buffer_store_dword v28, v15, s[32:35], s6 offen sc1
  s_mov_b64 exec, -1
Lff_97:
  s_mov_b64 exec, 0xffff
  buffer_store_dwordx2 v[134:135], v14, s[32:35], s61 offen sc1
  s_mov_b64 exec, -1
  ds_read_b128 v[24:27], v12 offset:0
  s_waitcnt lgkmcnt(0)
  v_min3_u32 v24, v24, v25, v26
  v_min_u32 v24, v24, v27
  v_cmp_gt_u32 vcc, 17, v24
  s_cbranch_vccnz Lspin_99
Lok_98:
  ds_read_b128 v[48:51], v3
  ds_read_b128 v[64:67], v3 offset:1024
  s_waitcnt lgkmcnt(1)
  v_mfma_f32_16x16x32_bf16 v[84:87], v[48:51], v[32:35], v[244:247]
  s_waitcnt lgkmcnt(0)
  v_mov_b32 v29, 18
  ds_write_b32 v13, v29
  v_mov_b32 v52, v64
  v_mov_b32 v53, v65
  v_mov_b32 v58, v66
  v_mov_b32 v59, v67
  s_mov_b32 s63, 0x3e8b97f6
  s_nop 1
  v_max3_f32 v128, v80, v81, v82
  v_max3_f32 v124, v76, v77, v78
  v_max3_f32 v128, v128, v83, v88
  v_max3_f32 v124, v124, v79, v84
  v_max3_f32 v128, v128, v89, v90
  v_max3_f32 v124, v124, v85, v86
  v_max_f32 v128, v128, v91
  v_max_f32 v124, v124, v87
  v_mov_b32 v130, v128
  v_mov_b32 v126, v124
  s_nop 0
  s_nop 0
  v_permlane32_swap_b32 v128, v130
  v_permlane32_swap_b32 v124, v126
  v_max_f32 v128, v128, v130
  v_max_f32 v124, v124, v126
  v_mov_b32 v130, v128
  v_mov_b32 v126, v124
  s_nop 0
  s_nop 0
  v_permlane16_swap_b32 v128, v130
  v_permlane16_swap_b32 v124, v126
  v_max_f32 v128, v128, v130
  v_max_f32 v124, v124, v126
  v_mul_f32 v128, s63, v128
  v_mul_f32 v124, s63, v124
  v_fma_f32 v88, v88, s63, -v128
  v_fma_f32 v84, v84, s63, -v124
  v_fma_f32 v80, v80, s63, -v128
  v_fma_f32 v76, v76, s63, -v124
  v_fma_f32 v89, v89, s63, -v128
  v_fma_f32 v85, v85, s63, -v124
  v_fma_f32 v81, v81, s63, -v128
  v_fma_f32 v77, v77, s63, -v124
  v_fma_f32 v90, v90, s63, -v128
  v_fma_f32 v86, v86, s63, -v124
  v_fma_f32 v82, v82, s63, -v128
  v_fma_f32 v78, v78, s63, -v124
  v_fma_f32 v91, v91, s63, -v128
  v_fma_f32 v87, v87, s63, -v124
  v_fma_f32 v83, v83, s63, -v128
  v_fma_f32 v79, v79, s63, -v124
  v_exp_f32 v88, v88
  v_exp_f32 v84, v84
  v_exp_f32 v80, v80
  v_exp_f32 v76, v76
  v_exp_f32 v89, v89
  v_exp_f32 v85, v85
  v_exp_f32 v81, v81
  v_exp_f32 v77, v77
  v_exp_f32 v90, v90
  v_exp_f32 v86, v86
  v_exp_f32 v82, v82
  v_exp_f32 v78, v78
  v_exp_f32 v91, v91
  v_exp_f32 v87, v87
  v_exp_f32 v83, v83
  v_exp_f32 v79, v79
  v_cvt_pk_bf16_f32 v96, v88, v89
  v_cvt_pk_bf16_f32 v92, v84, v85
  v_cvt_pk_bf16_f32 v97, v90, v91
  v_cvt_pk_bf16_f32 v93, v86, v87
  v_cvt_pk_bf16_f32 v98, v80, v81
  v_cvt_pk_bf16_f32 v94, v76, v77
  v_cvt_pk_bf16_f32 v99, v82, v83
  v_cvt_pk_bf16_f32 v95, v78, v79
  v_add_f32 v129, v88, v89
  v_add_f32 v125, v84, v85
  v_mfma_f32_16x16x32_bf16 v[108:111], v[54:57], v[96:99], 0
  v_mfma_f32_16x16x32_bf16 v[100:103], v[52:55], v[92:95], 0
  v_mfma_f32_16x16x32_bf16 v[112:115], v[60:63], v[96:99], 0
  v_mfma_f32_16x16x32_bf16 v[104:107], v[58:61], v[92:95], 0
  v_add_f32 v130, v90, v91
  v_add_f32 v126, v86, v87
  v_add_f32 v128, v80, v81
  v_add_f32 v124, v76, v77
  v_add_f32 v129, v129, v130
  v_add_f32 v125, v125, v126
  v_add_f32 v130, v82, v83
  v_add_f32 v126, v78, v79
  v_add_f32 v129, v129, v128
  v_add_f32 v125, v125, v124
  v_add_f32 v129, v129, v130
  v_add_f32 v125, v125, v126
  v_mov_b32 v130, v129
  v_mov_b32 v126, v125
  s_nop 0
  s_nop 0
  v_permlane32_swap_b32 v129, v130
  v_permlane32_swap_b32 v125, v126
  v_add_f32 v129, v129, v130
  v_add_f32 v125, v125, v126
  v_mov_b32 v130, v129
  v_mov_b32 v126, v125
  s_nop 0
  s_nop 0
  v_permlane16_swap_b32 v129, v130
  v_permlane16_swap_b32 v125, v126
  v_add_f32 v129, v129, v130
  v_add_f32 v125, v125, v126
  v_rcp_f32 v129, v129
  v_rcp_f32 v125, v125
  v_mul_f32 v129, v129, v133
  v_mul_f32 v125, v125, v132
  v_mul_f32 v108, v108, v129
  v_mul_f32 v100, v100, v125
  v_mul_f32 v109, v109, v129
  v_mul_f32 v101, v101, v125
  v_mul_f32 v110, v110, v129
  v_mul_f32 v102, v102, v125
  v_mul_f32 v111, v111, v129
  v_mul_f32 v103, v103, v125
  v_mul_f32 v112, v112, v129
  v_mul_f32 v104, v104, v125
  v_mul_f32 v113, v113, v129
  v_mul_f32 v105, v105, v125
  v_mul_f32 v114, v114, v129
  v_mul_f32 v106, v106, v125
  v_mul_f32 v115, v115, v129
  v_mul_f32 v107, v107, v125
  v_cvt_pk_bf16_f32 v120, v108, v109
  v_cvt_pk_bf16_f32 v116, v100, v101
  v_cvt_pk_bf16_f32 v121, v110, v111
  v_cvt_pk_bf16_f32 v117, v102, v103
  v_cvt_pk_bf16_f32 v122, v112, v113
  v_cvt_pk_bf16_f32 v118, v104, v105
  v_cvt_pk_bf16_f32 v123, v114, v115
  v_cvt_pk_bf16_f32 v119, v106, v107
  buffer_store_dwordx4 v[120:123], v14, s[32:35], s64 offen offset:1024 sc1
  buffer_store_dwordx4 v[116:119], v14, s[32:35], s64 offen offset:0 sc1
  s_add_u32 s63, s76, 13271040
  s_waitcnt vmcnt(0)
  s_mov_b64 exec, 1
  buffer_store_dword v28, v15, s[32:35], s63 offen sc1
  s_mov_b64 exec, -1
  s_endpgm
L_p2:
  s_lshl_b32 s60, s55, 7
  s_lshl_b32 s61, s68, 5
  s_add_u32 s60, s60, s61
  v_lshrrev_b32 v1, 3, v0
  v_add_u32 v1, s60, v1
  v_mul_u32_u24 v1, 896, v1
  v_and_b32 v2, 7, v0
  v_lshrrev_b32 v3, 4, v0
  v_xor_b32 v2, v2, v3
  v_lshl_add_u32 v29, v2, 4, v1
  v_xor_b32 v31, 64, v29
  v_and_b32 v6, 1, v3
  v_lshlrev_b32 v6, 2, v6
  v_and_b32 v7, 7, v0
  v_xor_b32 v6, v6, v7
  s_lshl_b32 s63, s68, 3
  v_lshrrev_b32 v4, 3, v0
  v_add_u32 v4, s63, v4
  v_mul_u32_u24 v4, 3584, v4
  v_lshl_add_u32 v4, v6, 4, v4
  s_lshl_b32 s63, s56, 8
  v_add_u32 v30, s63, v4
  s_and_b32 s59, s54, 7
  s_lshr_b32 s63, s54, 3
  s_lshl_b32 s63, s63, 1
  s_add_u32 s59, s59, s63
  s_sub_u32 s63, s59, 7
  s_cmp_ge_u32 s59, 7
  s_cselect_b32 s59, s63, s59
  s_mov_b32 s59, 0
  s_lshl_b32 s78, s68, 12
  s_lshl_b32 s79, s68, 10
  s_cmp_ge_u32 s56, 14
  s_cselect_b32 s77, 0x30000, 0
  v_lshlrev_b32 v10, 4, v0
  v_mov_b32 v11, 0
  v_mov_b32 v12, 161792
  s_lshl_b32 s60, s68, 2
  s_add_u32 s60, s60, 161808
  v_lshlrev_b32 v15, 2, v0
  v_add_u32 v15, 162048, v15
  v_writelane_b32 v15, s60, 0
  v_add_u32 v96, 0, v29
  v_add_u32 v97, 6144, v31
  v_add_u32 v98, 12288, v29
  v_add_u32 v99, 18432, v31
  s_waitcnt lgkmcnt(0)
  s_mov_b32 s65, 13407744
  s_load_dword s67, s[30:31], s65
  s_mov_b32 s36, s8
  s_and_b32 s37, s9, 0xffff
  s_mov_b32 s38, 1835008
  s_mov_b32 s39, 0x00020000
  s_cmp_ge_u32 s56, 14
  s_cbranch_scc1 Llnoa_100
  s_add_u32 m0, s78, 0
  s_lshl_b32 s71, s59, 7
  buffer_load_dwordx4 v96, s[36:39], s71 offen offset:0 lds
  buffer_load_dwordx4 v97, s[36:39], s71 offen offset:1024 lds
  buffer_load_dwordx4 v98, s[36:39], s71 offen offset:2048 lds
  buffer_load_dwordx4 v99, s[36:39], s71 offen offset:3072 lds
  s_mul_i32 s8, s59, 229376
  s_mov_b32 s40, s16
  s_and_b32 s41, s17, 0xffff
  s_mov_b32 s42, 1605632
  s_mov_b32 s43, 0x00020000
  s_add_u32 m0, s79, 65536
  s_add_u32 s70, s8, 0
  buffer_load_dwordx4 v30, s[40:43], s70 offen lds
  s_add_u32 m0, s79, 69632
  s_add_u32 s70, s8, 114688
  buffer_load_dwordx4 v30, s[40:43], s70 offen lds
  s_mov_b32 s32, s30
  s_and_b32 s33, s31, 0xffff
  s_mov_b32 s34, 13538944
  s_mov_b32 s35, 0x00020000
  s_mov_b64 s[72:73], s[20:21]
  s_mov_b64 s[28:29], s[12:13]
  s_mov_b32 s25, 0
  s_waitcnt lgkmcnt(0)
  s_add_u32 s67, s67, 1
  s_barrier
  s_add_u32 s96, s59, 1
  s_cmp_eq_u32 s96, 7
  s_cselect_b32 s96, 0, s96
  s_add_u32 s97, s96, 1
  s_cmp_eq_u32 s97, 7
  s_cselect_b32 s97, 0, s97
  s_add_u32 s98, s97, 1
  s_cmp_eq_u32 s98, 7
  s_cselect_b32 s98, 0, s98
  s_add_u32 s99, s98, 1
  s_cmp_eq_u32 s99, 7
  s_cselect_b32 s99, 0, s99
  s_add_u32 s100, s99, 1
  s_cmp_eq_u32 s100, 7
  s_cselect_b32 s100, 0, s100
  s_add_u32 s101, s100, 1
  s_cmp_eq_u32 s101, 7
  s_cselect_b32 s101, 0, s101
  s_add_u32 m0, s78, 16384
  s_lshl_b32 s71, s96, 7
  buffer_load_dwordx4 v96, s[36:39], s71 offen offset:0 lds
  buffer_load_dwordx4 v97, s[36:39], s71 offen offset:1024 lds
  buffer_load_dwordx4 v98, s[36:39], s71 offen offset:2048 lds
  buffer_load_dwordx4 v99, s[36:39], s71 offen offset:3072 lds
  s_mul_i32 s9, s96, 229376
  s_getreg_b32 s3, hwreg(HW_REG_IB_STS)
  s_bfe_u32 s4, s3, 0x20016
  s_and_b32 s3, s3, 15
  s_lshl4_add_u32 s7, s4, s3
  s_sub_u32 s3, 10, s7
  v_mov_b32 v14, s3
  ds_write_b32 v15, v14
  s_add_u32 m0, s79, 73728
  s_add_u32 s70, s9, 0
  buffer_load_dwordx4 v30, s[40:43], s70 offen lds
  s_add_u32 m0, s79, 77824
  s_add_u32 s70, s9, 114688
  buffer_load_dwordx4 v30, s[40:43], s70 offen lds
  s_getreg_b32 s3, hwreg(HW_REG_IB_STS)
  s_bfe_u32 s4, s3, 0x20016
  s_and_b32 s3, s3, 15
  s_lshl4_add_u32 s7, s4, s3
  s_sub_u32 s3, 12, s7
  v_mov_b32 v14, s3
  ds_write_b32 v15, v14
  s_and_b32 s57, s54, 3
  s_lshl_b32 s60, s53, 2
  s_add_u32 s57, s57, s60
  s_lshr_b32 s58, s54, 2
  v_and_b32 v3, 3, v0
  v_lshrrev_b32 v4, 2, v0
  v_lshrrev_b32 v5, 4, v0
  v_lshlrev_b32 v5, 1, v5
  v_mov_b32 v6, 180
  v_lshrrev_b32 v5, v5, v6
  v_and_b32 v5, 3, v5
  v_xor_b32 v5, v5, v3
  s_lshl_b32 s60, s55, 7
  s_sub_u32 s60, s60, 16
  s_max_i32 s60, s60, 0
  v_add_u32 v4, s60, v4
  v_mul_u32_u24 v4, 896, v4
  v_lshl_add_u32 v4, v5, 4, v4
  v_mov_b32 v5, 0x40000000
  s_cmp_eq_u32 s55, 0
  s_cselect_b64 vcc, -1, 0
  v_cndmask_b32 v28, v4, v5, vcc
  s_cmp_lt_u32 s68, 2
  s_cselect_b64 vcc, -1, 0
  v_cndmask_b32 v28, v28, v10, vcc
  s_cselect_b32 s48, s32, s36
  s_cselect_b32 s49, s33, s37
  s_cselect_b32 s50, s34, s38
  s_mov_b32 s51, 0x00020000
  s_mov_b32 s60, 6144
  s_cselect_b32 s17, s60, 64
  s_mul_i32 s15, s56, 86016
  s_lshl_b32 s60, s68, 10
  s_add_u32 s15, s15, s60
  s_add_u32 s15, s15, 11501568
  s_add_u32 s61, s15, 4096
  s_cmp_lt_u32 s68, 2
  s_cselect_b32 s16, s61, 0
  s_add_u32 s61, s60, 4096
  s_min_u32 s19, s61, 6144
  s_mov_b32 s18, s60
  s_lshl_b32 s24, s17, 1
  v_min_u32 v22, 13, v0
  v_lshlrev_b32 v22, 2, v22
  v_min_u32 v23, 17, v0
  v_lshlrev_b32 v23, 2, v23
  s_lshl_b32 s60, s56, 7
  s_add_u32 s20, s60, 13402112
  s_min_u32 s61, s58, 6
  s_lshl_b32 s61, s61, 2
  s_add_u32 s61, s61, s68
  s_lshl_b32 s61, s61, 7
  s_add_u32 s21, s61, 13404160
  v_mov_b32 v13, s67
  s_mov_b32 s44, s22
  s_and_b32 s45, s23, 0xffff
  s_mov_b32 s46, 896
  s_mov_b32 s47, 0x00020000
  v_lshrrev_b32 v4, 4, v0
  s_lshl_b32 s60, s58, 7
  v_lshl_add_u32 v4, v4, 3, s60
  v_mov_b32 v5, 0x40000000
  s_cmp_eq_u32 s68, 0
  s_cselect_b64 vcc, -1, 0
  v_cndmask_b32 v4, v5, v4, vcc
  buffer_load_dwordx2 v[240:241], v4, s[44:47], 0 offen offset:0
  buffer_load_dwordx2 v[242:243], v4, s[44:47], 0 offen offset:32
  buffer_load_dwordx2 v[244:245], v4, s[44:47], 0 offen offset:64
  buffer_load_dwordx2 v[246:247], v4, s[44:47], 0 offen offset:96
  s_add_u32 m0, s78, 32768
  s_lshl_b32 s71, s97, 7
  buffer_load_dwordx4 v96, s[36:39], s71 offen offset:0 lds
  buffer_load_dwordx4 v97, s[36:39], s71 offen offset:1024 lds
  buffer_load_dwordx4 v98, s[36:39], s71 offen offset:2048 lds
  buffer_load_dwordx4 v99, s[36:39], s71 offen offset:3072 lds
  s_mul_i32 s10, s97, 229376
  s_getreg_b32 s3, hwreg(HW_REG_IB_STS)
  s_bfe_u32 s4, s3, 0x20016
  s_and_b32 s3, s3, 15
  s_lshl4_add_u32 s7, s4, s3
  s_sub_u32 s3, 20, s7
  v_mov_b32 v14, s3
  ds_write_b32 v15, v14
  s_add_u32 m0, s79, 81920
  s_add_u32 s70, s10, 0
  buffer_load_dwordx4 v30, s[40:43], s70 offen lds
  s_add_u32 m0, s79, 86016
  s_add_u32 s70, s10, 114688
  buffer_load_dwordx4 v30, s[40:43], s70 offen lds
  s_getreg_b32 s3, hwreg(HW_REG_IB_STS)
  s_bfe_u32 s4, s3, 0x20016
  s_and_b32 s3, s3, 15
  s_lshl4_add_u32 s7, s4, s3
  s_sub_u32 s3, 22, s7
  v_mov_b32 v14, s3
  ds_write_b32 v15, v14
  s_add_u32 m0, s78, 49152
  s_lshl_b32 s71, s98, 7
  buffer_load_dwordx4 v96, s[36:39], s71 offen offset:0 lds
  buffer_load_dwordx4 v97, s[36:39], s71 offen offset:1024 lds
  buffer_load_dwordx4 v98, s[36:39], s71 offen offset:2048 lds
  buffer_load_dwordx4 v99, s[36:39], s71 offen offset:3072 lds
  s_mul_i32 s11, s98, 229376
  s_getreg_b32 s3, hwreg(HW_REG_IB_STS)
  s_bfe_u32 s4, s3, 0x20016
  s_and_b32 s3, s3, 15
  s_lshl4_add_u32 s7, s4, s3
  s_sub_u32 s3, 26, s7
  v_mov_b32 v14, s3
  ds_write_b32 v15, v14
  s_add_u32 m0, s79, 90112
  s_add_u32 s70, s11, 0
  buffer_load_dwordx4 v30, s[40:43], s70 offen lds
  s_add_u32 m0, s79, 94208
  s_add_u32 s70, s11, 114688
  buffer_load_dwordx4 v30, s[40:43], s70 offen lds
  s_getreg_b32 s3, hwreg(HW_REG_IB_STS)
  s_bfe_u32 s4, s3, 0x20016
  s_and_b32 s3, s3, 15
  s_lshl4_add_u32 s7, s4, s3
  s_sub_u32 s3, 28, s7
  v_mov_b32 v14, s3
  ds_write_b32 v15, v14
  s_cmp_lt_u32 s25, 2
  s_cbranch_scc1 Lwpf_104
Lwpd_103:
  s_add_u32 m0, s78, 0
  s_lshl_b32 s71, s99, 7
  buffer_load_dwordx4 v96, s[36:39], s71 offen offset:0 lds
  buffer_load_dwordx4 v97, s[36:39], s71 offen offset:1024 lds
  buffer_load_dwordx4 v98, s[36:39], s71 offen offset:2048 lds
  buffer_load_dwordx4 v99, s[36:39], s71 offen offset:3072 lds
  s_mul_i32 s12, s99, 229376
  s_getreg_b32 s3, hwreg(HW_REG_IB_STS)
  s_bfe_u32 s4, s3, 0x20016
  s_and_b32 s3, s3, 15
  s_lshl4_add_u32 s7, s4, s3
  s_sub_u32 s3, 32, s7
  v_mov_b32 v14, s3
  ds_write_b32 v15, v14
  s_add_u32 m0, s79, 98304
  s_add_u32 s70, s12, 0
  buffer_load_dwordx4 v30, s[40:43], s70 offen lds
  s_add_u32 m0, s79, 102400
  s_add_u32 s70, s12, 114688
  buffer_load_dwordx4 v30, s[40:43], s70 offen lds
  s_getreg_b32 s3, hwreg(HW_REG_IB_STS)
  s_bfe_u32 s4, s3, 0x20016
  s_and_b32 s3, s3, 15
  s_lshl4_add_u32 s7, s4, s3
  s_sub_u32 s3, 34, s7
  v_mov_b32 v14, s3
  ds_write_b32 v15, v14
  s_cmp_lt_u32 s25, 3
  s_cbranch_scc1 Lwpf_107
Lwpd_106:
  s_add_u32 m0, s78, 16384
  s_lshl_b32 s71, s100, 7
  buffer_load_dwordx4 v96, s[36:39], s71 offen offset:0 lds
  buffer_load_dwordx4 v97, s[36:39], s71 offen offset:1024 lds
  buffer_load_dwordx4 v98, s[36:39], s71 offen offset:2048 lds
  buffer_load_dwordx4 v99, s[36:39], s71 offen offset:3072 lds
  s_mul_i32 s13, s100, 229376
  s_getreg_b32 s3, hwreg(HW_REG_IB_STS)
  s_bfe_u32 s4, s3, 0x20016
  s_and_b32 s3, s3, 15
  s_lshl4_add_u32 s7, s4, s3
  s_sub_u32 s3, 38, s7
  v_mov_b32 v14, s3
  ds_write_b32 v15, v14
  s_add_u32 m0, s79, 106496
  s_add_u32 s70, s13, 0
  buffer_load_dwordx4 v30, s[40:43], s70 offen lds
  s_add_u32 m0, s79, 110592
  s_add_u32 s70, s13, 114688
  buffer_load_dwordx4 v30, s[40:43], s70 offen lds
  s_getreg_b32 s3, hwreg(HW_REG_IB_STS)
  s_bfe_u32 s4, s3, 0x20016
  s_and_b32 s3, s3, 15
  s_lshl4_add_u32 s7, s4, s3
  s_sub_u32 s3, 40, s7
  v_mov_b32 v14, s3
  ds_write_b32 v15, v14
  s_cmp_lt_u32 s25, 4
  s_cbranch_scc1 Lwpf_110
Lwpd_109:
  s_add_u32 m0, s78, 32768
  s_lshl_b32 s71, s101, 7
  buffer_load_dwordx4 v96, s[36:39], s71 offen offset:0 lds
  buffer_load_dwordx4 v97, s[36:39], s71 offen offset:1024 lds
  buffer_load_dwordx4 v98, s[36:39], s71 offen offset:2048 lds
  buffer_load_dwordx4 v99, s[36:39], s71 offen offset:3072 lds
  s_mul_i32 s14, s101, 229376
  s_getreg_b32 s3, hwreg(HW_REG_IB_STS)
  s_bfe_u32 s4, s3, 0x20016
  s_and_b32 s3, s3, 15
  s_lshl4_add_u32 s7, s4, s3
  s_sub_u32 s3, 44, s7
  v_mov_b32 v14, s3
  ds_write_b32 v15, v14
  s_add_u32 m0, s79, 114688
  s_add_u32 s70, s14, 0
  buffer_load_dwordx4 v30, s[40:43], s70 offen lds
  s_add_u32 m0, s79, 118784
  s_add_u32 s70, s14, 114688
  buffer_load_dwordx4 v30, s[40:43], s70 offen lds
  s_getreg_b32 s3, hwreg(HW_REG_IB_STS)
  s_bfe_u32 s4, s3, 0x20016
  s_and_b32 s3, s3, 15
  s_lshl4_add_u32 s7, s4, s3
  s_sub_u32 s3, 46, s7
  v_mov_b32 v14, s3
  ds_write_b32 v15, v14
  s_add_u32 m0, s79, 122880
  s_add_u32 s70, s8, 128
  buffer_load_dwordx4 v30, s[40:43], s70 offen lds
  s_add_u32 m0, s79, 126976
  s_add_u32 s70, s8, 114816
  buffer_load_dwordx4 v30, s[40:43], s70 offen lds
  s_getreg_b32 s3, hwreg(HW_REG_IB_STS)
  s_bfe_u32 s4, s3, 0x20016
  s_and_b32 s3, s3, 15
  s_lshl4_add_u32 s7, s4, s3
  s_sub_u32 s3, 48, s7
  v_mov_b32 v14, s3
  ds_write_b32 v15, v14
  s_add_u32 m0, s79, 131072
  s_add_u32 s70, s9, 128
  buffer_load_dwordx4 v30, s[40:43], s70 offen lds
  s_add_u32 m0, s79, 135168
  s_add_u32 s70, s9, 114816
  buffer_load_dwordx4 v30, s[40:43], s70 offen lds
  s_getreg_b32 s3, hwreg(HW_REG_IB_STS)
  s_bfe_u32 s4, s3, 0x20016
  s_and_b32 s3, s3, 15
  s_lshl4_add_u32 s7, s4, s3
  s_sub_u32 s3, 50, s7
  v_mov_b32 v14, s3
  ds_write_b32 v15, v14
  s_add_u32 m0, s79, 139264
  s_add_u32 s70, s10, 128
  buffer_load_dwordx4 v30, s[40:43], s70 offen lds
  s_add_u32 m0, s79, 143360
  s_add_u32 s70, s10, 114816
  buffer_load_dwordx4 v30, s[40:43], s70 offen lds
  s_getreg_b32 s3, hwreg(HW_REG_IB_STS)
  s_bfe_u32 s4, s3, 0x20016
  s_and_b32 s3, s3, 15
  s_lshl4_add_u32 s7, s4, s3
  s_sub_u32 s3, 52, s7
  v_mov_b32 v14, s3
  ds_write_b32 v15, v14
  s_cmp_lt_u32 s25, 5
  s_cbranch_scc1 Lwpf_113
Lwpd_112:
  s_add_u32 m0, s79, 49152
  s_add_u32 s70, s11, 128
  buffer_load_dwordx4 v30, s[40:43], s70 offen lds
  s_add_u32 m0, s79, 53248
  s_add_u32 s70, s11, 114816
  buffer_load_dwordx4 v30, s[40:43], s70 offen lds
  s_getreg_b32 s3, hwreg(HW_REG_IB_STS)
  s_bfe_u32 s4, s3, 0x20016
  s_and_b32 s3, s3, 15
  s_lshl4_add_u32 s7, s4, s3
  s_sub_u32 s3, 54, s7
  v_mov_b32 v14, s3
  ds_write_b32 v15, v14
  s_add_u32 m0, s79, 57344
  s_add_u32 s70, s12, 128
  buffer_load_dwordx4 v30, s[40:43], s70 offen lds
  buffer_load_dword v20, v22, s[32:35], s20 offen sc1
  s_add_u32 m0, s79, 61440
  s_add_u32 s70, s12, 114816
  buffer_load_dwordx4 v30, s[40:43], s70 offen lds
  s_getreg_b32 s3, hwreg(HW_REG_IB_STS)
  s_bfe_u32 s4, s3, 0x20016
  s_and_b32 s3, s3, 15
  s_lshl4_add_u32 s7, s4, s3
  s_sub_u32 s3, 57, s7
  v_mov_b32 v14, s3
  ds_write_b32 v15, v14
  s_cmp_lt_u32 s25, 6
  s_cbranch_scc1 Lwpf_116
Lwpd_115:
  s_add_u32 m0, s79, 0
  s_add_u32 s70, s13, 128
  buffer_load_dwordx4 v30, s[40:43], s70 offen lds
  s_add_u32 m0, s79, 4096
  s_add_u32 s70, s13, 114816
  buffer_load_dwordx4 v30, s[40:43], s70 offen lds
  s_getreg_b32 s3, hwreg(HW_REG_IB_STS)
  s_bfe_u32 s4, s3, 0x20016
  s_and_b32 s3, s3, 15
  s_lshl4_add_u32 s7, s4, s3
  s_sub_u32 s3, 59, s7
  v_mov_b32 v14, s3
  ds_write_b32 v15, v14
  s_add_u32 m0, s79, 8192
  s_add_u32 s70, s14, 128
  buffer_load_dwordx4 v30, s[40:43], s70 offen lds
  s_add_u32 m0, s79, 12288
  s_add_u32 s70, s14, 114816
  buffer_load_dwordx4 v30, s[40:43], s70 offen lds
  s_getreg_b32 s3, hwreg(HW_REG_IB_STS)
  s_bfe_u32 s4, s3, 0x20016
  s_and_b32 s3, s3, 15
  s_lshl4_add_u32 s7, s4, s3
  s_sub_u32 s3, 61, s7
  v_mov_b32 v14, s3
  ds_write_b32 v15, v14
  s_branch Lljoin_101
Llnoa_100:
  s_waitcnt lgkmcnt(0)
  s_add_u32 s67, s67, 1
  s_barrier
  s_add_u32 m0, s78, 0
  s_lshl_b32 s71, s59, 7
  buffer_load_dwordx4 v96, s[36:39], s71 offen offset:0 lds
  buffer_load_dwordx4 v97, s[36:39], s71 offen offset:1024 lds
  buffer_load_dwordx4 v98, s[36:39], s71 offen offset:2048 lds
  buffer_load_dwordx4 v99, s[36:39], s71 offen offset:3072 lds
  s_mul_i32 s8, s59, 229376
  s_mov_b32 s40, s16
  s_and_b32 s41, s17, 0xffff
  s_mov_b32 s42, 1605632
  s_mov_b32 s43, 0x00020000
  s_mov_b32 s32, s30
  s_and_b32 s33, s31, 0xffff
  s_mov_b32 s34, 13538944
  s_mov_b32 s35, 0x00020000
  s_mov_b64 s[72:73], s[20:21]
  s_mov_b64 s[28:29], s[12:13]
  s_mov_b32 s25, 0
  s_add_u32 s96, s59, 1
  s_cmp_eq_u32 s96, 7
  s_cselect_b32 s96, 0, s96
  s_add_u32 s97, s96, 1
  s_cmp_eq_u32 s97, 7
  s_cselect_b32 s97, 0, s97
  s_add_u32 s98, s97, 1
  s_cmp_eq_u32 s98, 7
  s_cselect_b32 s98, 0, s98
  s_add_u32 s99, s98, 1
  s_cmp_eq_u32 s99, 7
  s_cselect_b32 s99, 0, s99
  s_add_u32 s100, s99, 1
  s_cmp_eq_u32 s100, 7
  s_cselect_b32 s100, 0, s100
  s_add_u32 s101, s100, 1
  s_cmp_eq_u32 s101, 7
  s_cselect_b32 s101, 0, s101
  s_add_u32 m0, s78, 16384
  s_lshl_b32 s71, s96, 7
  buffer_load_dwordx4 v96, s[36:39], s71 offen offset:0 lds
  buffer_load_dwordx4 v97, s[36:39], s71 offen offset:1024 lds
  buffer_load_dwordx4 v98, s[36:39], s71 offen offset:2048 lds
  buffer_load_dwordx4 v99, s[36:39], s71 offen offset:3072 lds
  s_mul_i32 s9, s96, 229376
  s_getreg_b32 s3, hwreg(HW_REG_IB_STS)
  s_bfe_u32 s4, s3, 0x20016
  s_and_b32 s3, s3, 15
  s_lshl4_add_u32 s7, s4, s3
  s_sub_u32 s3, 8, s7
  v_mov_b32 v14, s3
  ds_write_b32 v15, v14
  s_and_b32 s57, s54, 3
  s_lshl_b32 s60, s53, 2
  s_add_u32 s57, s57, s60
  s_lshr_b32 s58, s54, 2
  v_and_b32 v3, 3, v0
  v_lshrrev_b32 v4, 2, v0
  v_lshrrev_b32 v5, 4, v0
  v_lshlrev_b32 v5, 1, v5
  v_mov_b32 v6, 180
  v_lshrrev_b32 v5, v5, v6
  v_and_b32 v5, 3, v5
  v_xor_b32 v5, v5, v3
  s_lshl_b32 s60, s55, 7
  s_sub_u32 s60, s60, 16
  s_max_i32 s60, s60, 0
  v_add_u32 v4, s60, v4
  v_mul_u32_u24 v4, 896, v4
  v_lshl_add_u32 v4, v5, 4, v4
  v_mov_b32 v5, 0x40000000
  s_cmp_eq_u32 s55, 0
  s_cselect_b64 vcc, -1, 0
  v_cndmask_b32 v28, v4, v5, vcc
  s_cmp_lt_u32 s68, 2
  s_cselect_b64 vcc, -1, 0
  v_cndmask_b32 v28, v28, v10, vcc
  s_cselect_b32 s48, s32, s36
  s_cselect_b32 s49, s33, s37
  s_cselect_b32 s50, s34, s38
  s_mov_b32 s51, 0x00020000
  s_mov_b32 s60, 6144
  s_cselect_b32 s17, s60, 64
  s_mul_i32 s15, s56, 86016
  s_lshl_b32 s60, s68, 10
  s_add_u32 s15, s15, s60
  s_add_u32 s15, s15, 11501568
  s_add_u32 s61, s15, 4096
  s_cmp_lt_u32 s68, 2
  s_cselect_b32 s16, s61, 0
  s_add_u32 s61, s60, 4096
  s_min_u32 s19, s61, 6144
  s_mov_b32 s18, s60
  s_lshl_b32 s24, s17, 1
  v_min_u32 v22, 13, v0
  v_lshlrev_b32 v22, 2, v22
  v_min_u32 v23, 17, v0
  v_lshlrev_b32 v23, 2, v23
  s_lshl_b32 s60, s56, 7
  s_add_u32 s20, s60, 13402112
  s_min_u32 s61, s58, 6
  s_lshl_b32 s61, s61, 2
  s_add_u32 s61, s61, s68
  s_lshl_b32 s61, s61, 7
  s_add_u32 s21, s61, 13404160
  v_mov_b32 v13, s67
  s_mov_b32 s44, s22
  s_and_b32 s45, s23, 0xffff
  s_mov_b32 s46, 896
  s_mov_b32 s47, 0x00020000
  v_lshrrev_b32 v4, 4, v0
  s_lshl_b32 s60, s58, 7
  v_lshl_add_u32 v4, v4, 3, s60
  v_mov_b32 v5, 0x40000000
  s_cmp_eq_u32 s68, 0
  s_cselect_b64 vcc, -1, 0
  v_cndmask_b32 v4, v5, v4, vcc
  buffer_load_dwordx2 v[240:241], v4, s[44:47], 0 offen offset:0
  buffer_load_dwordx2 v[242:243], v4, s[44:47], 0 offen offset:32
  buffer_load_dwordx2 v[244:245], v4, s[44:47], 0 offen offset:64
  buffer_load_dwordx2 v[246:247], v4, s[44:47], 0 offen offset:96
  s_add_u32 m0, s78, 32768
  s_lshl_b32 s71, s97, 7
  buffer_load_dwordx4 v96, s[36:39], s71 offen offset:0 lds
  buffer_load_dwordx4 v97, s[36:39], s71 offen offset:1024 lds
  buffer_load_dwordx4 v98, s[36:39], s71 offen offset:2048 lds
  buffer_load_dwordx4 v99, s[36:39], s71 offen offset:3072 lds
  s_mul_i32 s10, s97, 229376
  s_getreg_b32 s3, hwreg(HW_REG_IB_STS)
  s_bfe_u32 s4, s3, 0x20016
  s_and_b32 s3, s3, 15
  s_lshl4_add_u32 s7, s4, s3
  s_sub_u32 s3, 16, s7
  v_mov_b32 v14, s3
  ds_write_b32 v15, v14
  s_add_u32 m0, s78, 49152
  s_lshl_b32 s71, s98, 7
  buffer_load_dwordx4 v96, s[36:39], s71 offen offset:0 lds
  buffer_load_dwordx4 v97, s[36:39], s71 offen offset:1024 lds
  buffer_load_dwordx4 v98, s[36:39], s71 offen offset:2048 lds
  buffer_load_dwordx4 v99, s[36:39], s71 offen offset:3072 lds
  s_mul_i32 s11, s98, 229376
  s_getreg_b32 s3, hwreg(HW_REG_IB_STS)
  s_bfe_u32 s4, s3, 0x20016
  s_and_b32 s3, s3, 15
  s_lshl4_add_u32 s7, s4, s3
  s_sub_u32 s3, 20, s7
  v_mov_b32 v14, s3
  ds_write_b32 v15, v14
  s_cmp_lt_u32 s25, 2
  s_cbranch_scc1 Lwpf_119
Lwpd_118:
  s_add_u32 m0, s78, 0
  s_lshl_b32 s71, s99, 7
  buffer_load_dwordx4 v96, s[36:39], s71 offen offset:0 lds
  buffer_load_dwordx4 v97, s[36:39], s71 offen offset:1024 lds
  buffer_load_dwordx4 v98, s[36:39], s71 offen offset:2048 lds
  buffer_load_dwordx4 v99, s[36:39], s71 offen offset:3072 lds
  s_mul_i32 s12, s99, 229376
  s_getreg_b32 s3, hwreg(HW_REG_IB_STS)
  s_bfe_u32 s4, s3, 0x20016
  s_and_b32 s3, s3, 15
  s_lshl4_add_u32 s7, s4, s3
  s_sub_u32 s3, 24, s7
  v_mov_b32 v14, s3
  ds_write_b32 v15, v14
  s_cmp_lt_u32 s25, 3
  s_cbranch_scc1 Lwpf_122
Lwpd_121:
  s_add_u32 m0, s78, 16384
  s_lshl_b32 s71, s100, 7
  buffer_load_dwordx4 v96, s[36:39], s71 offen offset:0 lds
  buffer_load_dwordx4 v97, s[36:39], s71 offen offset:1024 lds
  buffer_load_dwordx4 v98, s[36:39], s71 offen offset:2048 lds
  buffer_load_dwordx4 v99, s[36:39], s71 offen offset:3072 lds
  s_mul_i32 s13, s100, 229376
  s_getreg_b32 s3, hwreg(HW_REG_IB_STS)
  s_bfe_u32 s4, s3, 0x20016
  s_and_b32 s3, s3, 15
  s_lshl4_add_u32 s7, s4, s3
  s_sub_u32 s3, 28, s7
  v_mov_b32 v14, s3
  ds_write_b32 v15, v14
  s_cmp_lt_u32 s25, 4
  s_cbranch_scc1 Lwpf_125
Lwpd_124:
  s_add_u32 m0, s78, 32768
  s_lshl_b32 s71, s101, 7
  buffer_load_dwordx4 v96, s[36:39], s71 offen offset:0 lds
  buffer_load_dwordx4 v97, s[36:39], s71 offen offset:1024 lds
  buffer_load_dwordx4 v98, s[36:39], s71 offen offset:2048 lds
  buffer_load_dwordx4 v99, s[36:39], s71 offen offset:3072 lds
  s_mul_i32 s14, s101, 229376
  s_getreg_b32 s3, hwreg(HW_REG_IB_STS)
  s_bfe_u32 s4, s3, 0x20016
  s_and_b32 s3, s3, 15
  s_lshl4_add_u32 s7, s4, s3
  s_sub_u32 s3, 32, s7
  v_mov_b32 v14, s3
  ds_write_b32 v15, v14
  buffer_load_dword v20, v22, s[32:35], s20 offen sc1
  s_branch Lwtd_127
Lwt_126:
  s_sleep 1
Lwtd_127:
  s_getreg_b32 s3, hwreg(HW_REG_IB_STS)
  s_bfe_u32 s4, s3, 0x20016
  s_and_b32 s3, s3, 15
  s_lshl4_add_u32 s7, s4, s3
  s_sub_u32 s3, 33, s7
  v_mov_b32 v14, s3
  ds_write_b32 v15, v14
  s_cmp_gt_u32 s7, 0
  s_cbranch_scc1 Lwt_126
  s_waitcnt vmcnt(0)
  s_getreg_b32 s3, hwreg(HW_REG_IB_STS)
  s_bfe_u32 s4, s3, 0x20016
  s_and_b32 s3, s3, 15
  s_lshl4_add_u32 s7, s4, s3
  s_sub_u32 s3, 61, s7
  v_mov_b32 v14, s3
  ds_write_b32 v15, v14
Lljoin_101:
  s_waitcnt vmcnt(45)
  v_lshlrev_b32 v32, 16, v240
  v_and_b32 v33, 0xffff0000, v240
  v_lshlrev_b32 v34, 16, v241
  v_and_b32 v35, 0xffff0000, v241
  v_lshlrev_b32 v48, 16, v242
  v_and_b32 v49, 0xffff0000, v242
  v_lshlrev_b32 v50, 16, v243
  v_and_b32 v51, 0xffff0000, v243
  v_lshlrev_b32 v64, 16, v244
  v_and_b32 v65, 0xffff0000, v244
  v_lshlrev_b32 v66, 16, v245
  v_and_b32 v67, 0xffff0000, v245
  v_lshlrev_b32 v80, 16, v246
  v_and_b32 v81, 0xffff0000, v246
  v_lshlrev_b32 v82, 16, v247
  v_and_b32 v83, 0xffff0000, v247
  s_branch Lwtd_129
Lwt_128:
  s_sleep 1
Lwtd_129:
  s_getreg_b32 s3, hwreg(HW_REG_IB_STS)
  s_bfe_u32 s4, s3, 0x20016
  s_and_b32 s3, s3, 15
  s_lshl4_add_u32 s7, s4, s3
  s_sub_u32 s3, 61, s7
  v_mov_b32 v14, s3
  ds_write_b32 v15, v14
  s_cmp_gt_u32 s7, 5
  s_cbranch_scc1 Lwt_128
  s_waitcnt vmcnt(5)
  v_cmp_ne_u32 vcc, v20, v13
  s_cbranch_vccnz Lgslow_131
Lgok_130:
  s_cmp_lt_u32 s25, 3
  s_cbranch_scc1 Lwpf_134
Lwpd_133:
  s_mul_i32 s70, s59, 12288
  s_mul_i32 s71, s59, s24
  s_add_u32 s70, s70, s15
  s_add_u32 s71, s71, s16
  s_add_u32 m0, s18, 65536
  s_nop 0
  buffer_load_dwordx4 v10, s[32:35], s70 offen sc1 lds
  s_add_u32 m0, s19, 65536
  s_nop 0
  buffer_load_dwordx4 v28, s[48:51], s71 offen sc1 lds
  s_getreg_b32 s3, hwreg(HW_REG_IB_STS)
  s_bfe_u32 s4, s3, 0x20016
  s_and_b32 s3, s3, 15
  s_lshl4_add_u32 s7, s4, s3
  s_sub_u32 s3, 63, s7
  v_mov_b32 v14, s3
  ds_write_b32 v15, v14
  s_cmp_lt_u32 s25, 4
  s_cbranch_scc1 Lwpf_137
Lwpd_136:
  s_add_u32 s70, s70, 6144
  s_add_u32 s71, s71, s17
  s_add_u32 m0, s18, 72704
  s_nop 0
  buffer_load_dwordx4 v10, s[32:35], s70 offen sc1 lds
  s_add_u32 m0, s19, 72704
  s_nop 0
  buffer_load_dwordx4 v28, s[48:51], s71 offen sc1 lds
  s_getreg_b32 s3, hwreg(HW_REG_IB_STS)
  s_bfe_u32 s4, s3, 0x20016
  s_and_b32 s3, s3, 15
  s_lshl4_add_u32 s7, s4, s3
  s_sub_u32 s3, 65, s7
  v_mov_b32 v14, s3
  ds_write_b32 v15, v14
  s_cmp_lt_u32 s25, 5
  s_cbranch_scc1 Lwpf_140
Lwpd_139:
  s_mul_i32 s70, s96, 12288
  s_mul_i32 s71, s96, s24
  s_add_u32 s70, s70, s15
  s_add_u32 s71, s71, s16
  s_add_u32 m0, s18, 79872
  s_nop 0
  buffer_load_dwordx4 v10, s[32:35], s70 offen sc1 lds
  s_add_u32 m0, s19, 79872
  s_nop 0
  buffer_load_dwordx4 v28, s[48:51], s71 offen sc1 lds
  s_getreg_b32 s3, hwreg(HW_REG_IB_STS)
  s_bfe_u32 s4, s3, 0x20016
  s_and_b32 s3, s3, 15
  s_lshl4_add_u32 s7, s4, s3
  s_sub_u32 s3, 67, s7
  v_mov_b32 v14, s3
  ds_write_b32 v15, v14
  s_cmp_lt_u32 s25, 6
  s_cbranch_scc1 Lwpf_143
Lwpd_142:
  s_add_u32 s70, s70, 6144
  s_add_u32 s71, s71, s17
  s_add_u32 m0, s18, 87040
  s_nop 0
  buffer_load_dwordx4 v10, s[32:35], s70 offen sc1 lds
  s_add_u32 m0, s19, 87040
  s_nop 0
  buffer_load_dwordx4 v28, s[48:51], s71 offen sc1 lds
  s_getreg_b32 s3, hwreg(HW_REG_IB_STS)
  s_bfe_u32 s4, s3, 0x20016
  s_and_b32 s3, s3, 15
  s_lshl4_add_u32 s7, s4, s3
  s_sub_u32 s3, 69, s7
  v_mov_b32 v14, s3
  ds_write_b32 v15, v14
  s_cmp_lt_u32 s25, 7
  s_cbranch_scc1 Lwpf_146
Lwpd_145:
  s_mul_i32 s70, s97, 12288
  s_mul_i32 s71, s97, s24
  s_add_u32 s70, s70, s15
  s_add_u32 s71, s71, s16
  s_add_u32 m0, s18, 94208
  s_nop 0
  buffer_load_dwordx4 v10, s[32:35], s70 offen sc1 lds
  s_add_u32 m0, s19, 94208
  s_nop 0
  buffer_load_dwordx4 v28, s[48:51], s71 offen sc1 lds
  s_getreg_b32 s3, hwreg(HW_REG_IB_STS)
  s_bfe_u32 s4, s3, 0x20016
  s_and_b32 s3, s3, 15
  s_lshl4_add_u32 s7, s4, s3
  s_sub_u32 s3, 71, s7
  v_mov_b32 v14, s3
  ds_write_b32 v15, v14
  s_cmp_lt_u32 s25, 8
  s_cbranch_scc1 Lwpf_149
Lwpd_148:
  s_add_u32 s70, s70, 6144
  s_add_u32 s71, s71, s17
  s_add_u32 m0, s18, 101376
  s_nop 0
  buffer_load_dwordx4 v10, s[32:35], s70 offen sc1 lds
  s_add_u32 m0, s19, 101376
  s_nop 0
  buffer_load_dwordx4 v28, s[48:51], s71 offen sc1 lds
  s_getreg_b32 s3, hwreg(HW_REG_IB_STS)
  s_bfe_u32 s4, s3, 0x20016
  s_and_b32 s3, s3, 15
  s_lshl4_add_u32 s7, s4, s3
  s_sub_u32 s3, 73, s7
  v_mov_b32 v14, s3
  ds_write_b32 v15, v14
  s_cmp_lt_u32 s25, 9
  s_cbranch_scc1 Lwpf_152
Lwpd_151:
  s_mul_i32 s70, s98, 12288
  s_mul_i32 s71, s98, s24
  s_add_u32 s70, s70, s15
  s_add_u32 s71, s71, s16
  s_add_u32 m0, s18, 108544
  s_nop 0
  buffer_load_dwordx4 v10, s[32:35], s70 offen sc1 lds
  s_add_u32 m0, s19, 108544
  s_nop 0
  buffer_load_dwordx4 v28, s[48:51], s71 offen sc1 lds
  s_getreg_b32 s3, hwreg(HW_REG_IB_STS)
  s_bfe_u32 s4, s3, 0x20016
  s_and_b32 s3, s3, 15
  s_lshl4_add_u32 s7, s4, s3
  s_sub_u32 s3, 75, s7
  v_mov_b32 v14, s3
  ds_write_b32 v15, v14
  s_add_u32 s70, s70, 6144
  s_add_u32 s71, s71, s17
  s_add_u32 m0, s18, 115712
  s_nop 0
  buffer_load_dwordx4 v10, s[32:35], s70 offen sc1 lds
  s_add_u32 m0, s19, 115712
  s_nop 0
  buffer_load_dwordx4 v28, s[48:51], s71 offen sc1 lds
  s_getreg_b32 s3, hwreg(HW_REG_IB_STS)
  s_bfe_u32 s4, s3, 0x20016
  s_and_b32 s3, s3, 15
  s_lshl4_add_u32 s7, s4, s3
  s_sub_u32 s3, 77, s7
  v_mov_b32 v14, s3
  ds_write_b32 v15, v14
  s_mul_i32 s70, s99, 12288
  s_mul_i32 s71, s99, s24
  s_add_u32 s70, s70, s15
  s_add_u32 s71, s71, s16
  s_add_u32 m0, s18, 16384
  s_nop 0
  buffer_load_dwordx4 v10, s[32:35], s70 offen sc1 lds
  s_add_u32 m0, s19, 16384
  s_nop 0
  buffer_load_dwordx4 v28, s[48:51], s71 offen sc1 lds
  s_getreg_b32 s3, hwreg(HW_REG_IB_STS)
  s_bfe_u32 s4, s3, 0x20016
  s_and_b32 s3, s3, 15
  s_lshl4_add_u32 s7, s4, s3
  s_sub_u32 s3, 79, s7
  v_mov_b32 v14, s3
  ds_write_b32 v15, v14
  s_add_u32 s70, s70, 6144
  s_add_u32 s71, s71, s17
  s_add_u32 m0, s18, 23552
  s_nop 0
  buffer_load_dwordx4 v10, s[32:35], s70 offen sc1 lds
  s_add_u32 m0, s19, 23552
  s_nop 0
  buffer_load_dwordx4 v28, s[48:51], s71 offen sc1 lds
  s_getreg_b32 s3, hwreg(HW_REG_IB_STS)
  s_bfe_u32 s4, s3, 0x20016
  s_and_b32 s3, s3, 15
  s_lshl4_add_u32 s7, s4, s3
  s_sub_u32 s3, 81, s7
  v_mov_b32 v14, s3
  ds_write_b32 v15, v14
  buffer_load_dword v21, v23, s[32:35], s21 offen sc1
  s_mul_i32 s70, s100, 12288
  s_mul_i32 s71, s100, s24
  s_add_u32 s70, s70, s15
  s_add_u32 s71, s71, s16
  s_add_u32 m0, s18, 30720
  s_nop 0
  buffer_load_dwordx4 v10, s[32:35], s70 offen sc1 lds
  s_add_u32 m0, s19, 30720
  s_nop 0
  buffer_load_dwordx4 v28, s[48:51], s71 offen sc1 lds
  s_getreg_b32 s3, hwreg(HW_REG_IB_STS)
  s_bfe_u32 s4, s3, 0x20016
  s_and_b32 s3, s3, 15
  s_lshl4_add_u32 s7, s4, s3
  s_sub_u32 s3, 84, s7
  v_mov_b32 v14, s3
  ds_write_b32 v15, v14
  s_add_u32 s70, s70, 6144
  s_add_u32 s71, s71, s17
  s_add_u32 m0, s18, 37888
  s_nop 0
  buffer_load_dwordx4 v10, s[32:35], s70 offen sc1 lds
  s_add_u32 m0, s19, 37888
  s_nop 0
  buffer_load_dwordx4 v28, s[48:51], s71 offen sc1 lds
  s_getreg_b32 s3, hwreg(HW_REG_IB_STS)
  s_bfe_u32 s4, s3, 0x20016
  s_and_b32 s3, s3, 15
  s_lshl4_add_u32 s7, s4, s3
  s_sub_u32 s3, 86, s7
  v_mov_b32 v14, s3
  ds_write_b32 v15, v14
  s_cmp_lt_u32 s25, 10
  s_cbranch_scc1 Lwpf_155
Lwpd_154:
  s_mul_i32 s70, s101, 12288
  s_mul_i32 s71, s101, s24
  s_add_u32 s70, s70, s15
  s_add_u32 s71, s71, s16
  s_add_u32 m0, s18, 122880
  s_nop 0
  buffer_load_dwordx4 v10, s[32:35], s70 offen sc1 lds
  s_add_u32 m0, s19, 122880
  s_nop 0
  buffer_load_dwordx4 v28, s[48:51], s71 offen sc1 lds
  s_getreg_b32 s3, hwreg(HW_REG_IB_STS)
  s_bfe_u32 s4, s3, 0x20016
  s_and_b32 s3, s3, 15
  s_lshl4_add_u32 s7, s4, s3
  s_sub_u32 s3, 88, s7
  v_mov_b32 v14, s3
  ds_write_b32 v15, v14
  s_cmp_lt_u32 s25, 11
  s_cbranch_scc1 Lwpf_158
Lwpd_157:
  s_add_u32 s70, s70, 6144
  s_add_u32 s71, s71, s17
  s_add_u32 m0, s18, 130048
  s_nop 0
  buffer_load_dwordx4 v10, s[32:35], s70 offen sc1 lds
  s_add_u32 m0, s19, 130048
  s_nop 0
  buffer_load_dwordx4 v28, s[48:51], s71 offen sc1 lds
  s_getreg_b32 s3, hwreg(HW_REG_IB_STS)
  s_bfe_u32 s4, s3, 0x20016
  s_and_b32 s3, s3, 15
  s_lshl4_add_u32 s7, s4, s3
  s_sub_u32 s3, 90, s7
  v_mov_b32 v14, s3
  ds_write_b32 v15, v14
  s_cmp_ge_u32 s58, 7
  s_cbranch_scc1 LnoP2_159
  s_getreg_b32 s3, hwreg(HW_REG_IB_STS)
  s_bfe_u32 s4, s3, 0x20016
  s_and_b32 s3, s3, 15
  s_lshl4_add_u32 s7, s4, s3
  s_sub_u32 s3, 90, s7
  v_mov_b32 v14, s3
  ds_write_b32 v15, v14
  s_branch Lwtd_161
Lwt_160:
  s_sleep 1
Lwtd_161:
  s_getreg_b32 s3, hwreg(HW_REG_IB_STS)
  s_bfe_u32 s4, s3, 0x20016
  s_and_b32 s3, s3, 15
  s_lshl4_add_u32 s7, s4, s3
  s_sub_u32 s3, 90, s7
  v_mov_b32 v14, s3
  ds_write_b32 v15, v14
  s_cmp_gt_u32 s7, 8
  s_cbranch_scc1 Lwt_160
  s_waitcnt vmcnt(8)
  v_cmp_ne_u32 vcc, v21, v13
  s_cbranch_vccnz Lgslow_163
Lgok_162:
  s_mov_b32 s40, s72
  s_and_b32 s41, s73, 0xffff
  s_mov_b32 s42, 1605632
  s_mov_b32 s43, 0x00020000
  s_mov_b32 s36, s28
  s_and_b32 s37, s29, 0xffff
  s_mov_b32 s38, 401408
  s_mov_b32 s39, 0x00020000
  s_mul_i32 s72, s57, 294912
  s_mul_i32 s60, s68, 28672
  s_lshl_b32 s61, s68, 14
  s_add_u32 s61, s61, 229376
  s_add_u32 s74, s72, s60
  s_add_u32 s75, s72, s61
  s_lshl_b32 s65, s58, 7
  s_mul_i32 s76, s68, 100352
  s_add_u32 s76, s76, s65
  s_and_b32 s60, s57, 3
  s_lshl_b32 s60, s60, 1
  s_add_u32 s60, s60, s58
  s_sub_u32 s61, s60, 7
  s_cmp_ge_u32 s60, 7
  s_cselect_b32 s60, s61, s60
  s_mul_i32 s64, s68, 7
  s_lshl_b32 s8, s60, 12
  s_add_u32 s60, s60, 1
  s_cmp_eq_u32 s60, 7
  s_cselect_b32 s60, 0, s60
  s_lshl_b32 s9, s60, 12
  s_add_u32 s60, s60, 1
  s_cmp_eq_u32 s60, 7
  s_cselect_b32 s60, 0, s60
  s_lshl_b32 s10, s60, 12
  s_add_u32 s60, s60, 1
  s_cmp_eq_u32 s60, 7
  s_cselect_b32 s60, 0, s60
  s_lshl_b32 s11, s60, 12
  s_add_u32 s60, s60, 1
  s_cmp_eq_u32 s60, 7
  s_cselect_b32 s60, 0, s60
  s_lshl_b32 s12, s60, 12
  s_add_u32 s60, s60, 1
  s_cmp_eq_u32 s60, 7
  s_cselect_b32 s60, 0, s60
  s_lshl_b32 s13, s60, 12
  s_add_u32 s60, s60, 1
  s_cmp_eq_u32 s60, 7
  s_cselect_b32 s60, 0, s60
  s_lshl_b32 s14, s60, 12
  s_mul_i32 s60, s68, 7
  s_lshr_b32 s60, s60, 1
  s_lshl_b32 s60, s60, 8
  s_lshl_b32 s61, s57, 12
  s_add_u32 s60, s60, s61
  s_add_u32 s77, s60, 13008896
  s_add_u32 s6, s77, 131072
  v_and_b32 v9, 7, v0
  v_lshlrev_b32 v9, 7, v9
  s_lshl_b32 s62, s68, 10
  s_add_u32 s78, s62, s61
  s_add_u32 s78, s78, 13271040
  s_lshl_b32 s62, s68, 7
  s_add_u32 s62, s62, s57
  s_lshl_b32 s62, s62, 8
  s_add_u32 s79, s62, 12877824
  v_and_b32 v23, 15, v0
  v_lshlrev_b32 v23, 4, v23
  s_mul_i32 s60, s58, 294912
  s_add_u32 s60, s60, 9437184
  s_mul_i32 s61, s68, 28672
  s_add_u32 s22, s60, s61
  s_lshl_b32 s61, s68, 14
  s_add_u32 s61, s61, 229376
  s_add_u32 s23, s60, s61
  s_getreg_b32 s3, hwreg(HW_REG_IB_STS)
  s_bfe_u32 s4, s3, 0x20016
  s_and_b32 s3, s3, 15
  s_lshl4_add_u32 s7, s4, s3
  s_sub_u32 s3, 90, s7
  v_mov_b32 v14, s3
  ds_write_b32 v15, v14
  v_mov_b32 v36, v32
  v_mov_b32 v37, v33
  v_mov_b32 v38, v34
  v_mov_b32 v39, v35
  v_mov_b32 v40, v32
  v_mov_b32 v41, v33
  v_mov_b32 v42, v34
  v_mov_b32 v43, v35
  v_mov_b32 v44, v32
  v_mov_b32 v45, v33
  v_mov_b32 v46, v34
  v_mov_b32 v47, v35
  s_getreg_b32 s3, hwreg(HW_REG_IB_STS)
  s_bfe_u32 s4, s3, 0x20016
  s_and_b32 s3, s3, 15
  s_lshl4_add_u32 s7, s4, s3
  s_sub_u32 s3, 90, s7
  v_mov_b32 v14, s3
  ds_write_b32 v15, v14
  v_mov_b32 v52, v48
  v_mov_b32 v53, v49
  v_mov_b32 v54, v50
  v_mov_b32 v55, v51
  v_mov_b32 v56, v48
  v_mov_b32 v57, v49
  v_mov_b32 v58, v50
  v_mov_b32 v59, v51
  v_mov_b32 v60, v48
  v_mov_b32 v61, v49
  v_mov_b32 v62, v50
  v_mov_b32 v63, v51
  s_getreg_b32 s3, hwreg(HW_REG_IB_STS)
  s_bfe_u32 s4, s3, 0x20016
  s_and_b32 s3, s3, 15
  s_lshl4_add_u32 s7, s4, s3
  s_sub_u32 s3, 90, s7
  v_mov_b32 v14, s3
  ds_write_b32 v15, v14
  v_mov_b32 v68, v64
  v_mov_b32 v69, v65
  v_mov_b32 v70, v66
  v_mov_b32 v71, v67
  v_mov_b32 v72, v64
  v_mov_b32 v73, v65
  v_mov_b32 v74, v66
  v_mov_b32 v75, v67
  v_mov_b32 v76, v64
  v_mov_b32 v77, v65
  v_mov_b32 v78, v66
  v_mov_b32 v79, v67
  s_getreg_b32 s3, hwreg(HW_REG_IB_STS)
  s_bfe_u32 s4, s3, 0x20016
  s_and_b32 s3, s3, 15
  s_lshl4_add_u32 s7, s4, s3
  s_sub_u32 s3, 90, s7
  v_mov_b32 v14, s3
  ds_write_b32 v15, v14
  v_mov_b32 v84, v80
  v_mov_b32 v85, v81
  v_mov_b32 v86, v82
  v_mov_b32 v87, v83
  v_mov_b32 v88, v80
  v_mov_b32 v89, v81
  v_mov_b32 v90, v82
  v_mov_b32 v91, v83
  v_mov_b32 v92, v80
  v_mov_b32 v93, v81
  v_mov_b32 v94, v82
  v_mov_b32 v95, v83
  s_getreg_b32 s3, hwreg(HW_REG_IB_STS)
  s_bfe_u32 s4, s3, 0x20016
  s_and_b32 s3, s3, 15
  s_lshl4_add_u32 s7, s4, s3
  s_sub_u32 s3, 90, s7
  v_mov_b32 v14, s3
  ds_write_b32 v15, v14
  s_cmp_ge_u32 s58, 7
  s_cselect_b32 s42, 0, s42
  s_add_u32 s70, s22, s8
  buffer_load_dwordx4 v[96:99], v10, s[32:35], s70 offen offset:0 sc1
  buffer_load_dwordx4 v[100:103], v10, s[32:35], s70 offen offset:1024 sc1
  s_getreg_b32 s3, hwreg(HW_REG_IB_STS)
  s_bfe_u32 s4, s3, 0x20016
  s_and_b32 s3, s3, 15
  s_lshl4_add_u32 s7, s4, s3
  s_sub_u32 s3, 92, s7
  v_mov_b32 v14, s3
  ds_write_b32 v15, v14
  buffer_load_dwordx4 v[104:107], v10, s[32:35], s70 offen offset:2048 sc1
  buffer_load_dwordx4 v[108:111], v10, s[32:35], s70 offen offset:3072 sc1
  s_getreg_b32 s3, hwreg(HW_REG_IB_STS)
  s_bfe_u32 s4, s3, 0x20016
  s_and_b32 s3, s3, 15
  s_lshl4_add_u32 s7, s4, s3
  s_sub_u32 s3, 94, s7
  v_mov_b32 v14, s3
  ds_write_b32 v15, v14
  s_add_u32 s70, s22, s9
  buffer_load_dwordx4 v[112:115], v10, s[32:35], s70 offen offset:0 sc1
  buffer_load_dwordx4 v[116:119], v10, s[32:35], s70 offen offset:1024 sc1
  s_getreg_b32 s3, hwreg(HW_REG_IB_STS)
  s_bfe_u32 s4, s3, 0x20016
  s_and_b32 s3, s3, 15
  s_lshl4_add_u32 s7, s4, s3
  s_sub_u32 s3, 96, s7
  v_mov_b32 v14, s3
  ds_write_b32 v15, v14
  buffer_load_dwordx4 v[120:123], v10, s[32:35], s70 offen offset:2048 sc1
  buffer_load_dwordx4 v[124:127], v10, s[32:35], s70 offen offset:3072 sc1
  s_getreg_b32 s3, hwreg(HW_REG_IB_STS)
  s_bfe_u32 s4, s3, 0x20016
  s_and_b32 s3, s3, 15
  s_lshl4_add_u32 s7, s4, s3
  s_sub_u32 s3, 98, s7
  v_mov_b32 v14, s3
  ds_write_b32 v15, v14
  s_add_u32 s70, s22, s10
  buffer_load_dwordx4 v[128:131], v10, s[32:35], s70 offen offset:0 sc1
  buffer_load_dwordx4 v[132:135], v10, s[32:35], s70 offen offset:1024 sc1
  s_getreg_b32 s3, hwreg(HW_REG_IB_STS)
  s_bfe_u32 s4, s3, 0x20016
  s_and_b32 s3, s3, 15
  s_lshl4_add_u32 s7, s4, s3
  s_sub_u32 s3, 100, s7
  v_mov_b32 v14, s3
  ds_write_b32 v15, v14
  buffer_load_dwordx4 v[136:139], v10, s[32:35], s70 offen offset:2048 sc1
  buffer_load_dwordx4 v[140:143], v10, s[32:35], s70 offen offset:3072 sc1
  s_getreg_b32 s3, hwreg(HW_REG_IB_STS)
  s_bfe_u32 s4, s3, 0x20016
  s_and_b32 s3, s3, 15
  s_lshl4_add_u32 s7, s4, s3
  s_sub_u32 s3, 102, s7
  v_mov_b32 v14, s3
  ds_write_b32 v15, v14
  s_add_u32 s70, s22, s11
  buffer_load_dwordx4 v[144:147], v10, s[32:35], s70 offen offset:0 sc1
  buffer_load_dwordx4 v[148:151], v10, s[32:35], s70 offen offset:1024 sc1
  s_getreg_b32 s3, hwreg(HW_REG_IB_STS)
  s_bfe_u32 s4, s3, 0x20016
  s_and_b32 s3, s3, 15
  s_lshl4_add_u32 s7, s4, s3
  s_sub_u32 s3, 104, s7
  v_mov_b32 v14, s3
  ds_write_b32 v15, v14
  buffer_load_dwordx4 v[152:155], v10, s[32:35], s70 offen offset:2048 sc1
  buffer_load_dwordx4 v[156:159], v10, s[32:35], s70 offen offset:3072 sc1
  s_getreg_b32 s3, hwreg(HW_REG_IB_STS)
  s_bfe_u32 s4, s3, 0x20016
  s_and_b32 s3, s3, 15
  s_lshl4_add_u32 s7, s4, s3
  s_sub_u32 s3, 106, s7
  v_mov_b32 v14, s3
  ds_write_b32 v15, v14
  buffer_load_dword v20, v9, s[32:35], s77 offen sc1
  s_add_u32 s70, s22, s12
  buffer_load_dwordx4 v[160:163], v10, s[32:35], s70 offen offset:0 sc1
  buffer_load_dwordx4 v[164:167], v10, s[32:35], s70 offen offset:1024 sc1
  s_getreg_b32 s3, hwreg(HW_REG_IB_STS)
  s_bfe_u32 s4, s3, 0x20016
  s_and_b32 s3, s3, 15
  s_lshl4_add_u32 s7, s4, s3
  s_sub_u32 s3, 109, s7
  v_mov_b32 v14, s3
  ds_write_b32 v15, v14
  buffer_load_dwordx4 v[168:171], v10, s[32:35], s70 offen offset:2048 sc1
  buffer_load_dwordx4 v[172:175], v10, s[32:35], s70 offen offset:3072 sc1
  s_getreg_b32 s3, hwreg(HW_REG_IB_STS)
  s_bfe_u32 s4, s3, 0x20016
  s_and_b32 s3, s3, 15
  s_lshl4_add_u32 s7, s4, s3
  s_sub_u32 s3, 111, s7
  v_mov_b32 v14, s3
  ds_write_b32 v15, v14
  s_add_u32 s70, s22, s13
  buffer_load_dwordx4 v[176:179], v10, s[32:35], s70 offen offset:0 sc1
  buffer_load_dwordx4 v[180:183], v10, s[32:35], s70 offen offset:1024 sc1
  s_getreg_b32 s3, hwreg(HW_REG_IB_STS)
  s_bfe_u32 s4, s3, 0x20016
  s_and_b32 s3, s3, 15
  s_lshl4_add_u32 s7, s4, s3
  s_sub_u32 s3, 113, s7
  v_mov_b32 v14, s3
  ds_write_b32 v15, v14
  buffer_load_dwordx4 v[184:187], v10, s[32:35], s70 offen offset:2048 sc1
  buffer_load_dwordx4 v[188:191], v10, s[32:35], s70 offen offset:3072 sc1
  s_getreg_b32 s3, hwreg(HW_REG_IB_STS)
  s_bfe_u32 s4, s3, 0x20016
  s_and_b32 s3, s3, 15
  s_lshl4_add_u32 s7, s4, s3
  s_sub_u32 s3, 115, s7
  v_mov_b32 v14, s3
  ds_write_b32 v15, v14
  s_branch Lwtd_165
Lwt_164:
  s_sleep 1
Lwtd_165:
  s_getreg_b32 s3, hwreg(HW_REG_IB_STS)
  s_bfe_u32 s4, s3, 0x20016
  s_and_b32 s3, s3, 15
  s_lshl4_add_u32 s7, s4, s3
  s_sub_u32 s3, 115, s7
  v_mov_b32 v14, s3
  ds_write_b32 v15, v14
  s_cmp_gt_u32 s7, 8
  s_cbranch_scc1 Lwt_164
  s_waitcnt vmcnt(8)
  v_cmp_ne_u32 vcc, v20, v13
  s_cbranch_vccnz Lgslow_167
Lgok_166:
  s_getreg_b32 s3, hwreg(HW_REG_IB_STS)
  s_bfe_u32 s4, s3, 0x20016
  s_and_b32 s3, s3, 15
  s_lshl4_add_u32 s7, s4, s3
  s_sub_u32 s3, 115, s7
  v_mov_b32 v14, s3
  ds_write_b32 v15, v14
  s_add_u32 s71, s74, s8
  buffer_load_dwordx4 v[192:195], v10, s[32:35], s71 offen offset:0 sc1
  buffer_load_dwordx4 v[196:199], v10, s[32:35], s71 offen offset:1024 sc1
  buffer_load_dwordx4 v[200:203], v10, s[32:35], s71 offen offset:2048 sc1
  buffer_load_dwordx4 v[204:207], v10, s[32:35], s71 offen offset:3072 sc1
  s_add_u32 s71, s74, s9
  buffer_load_dwordx4 v[208:211], v10, s[32:35], s71 offen offset:0 sc1
  buffer_load_dwordx4 v[212:215], v10, s[32:35], s71 offen offset:1024 sc1
  buffer_load_dwordx4 v[216:219], v10, s[32:35], s71 offen offset:2048 sc1
  buffer_load_dwordx4 v[220:223], v10, s[32:35], s71 offen offset:3072 sc1
  s_add_u32 s71, s74, s10
  buffer_load_dwordx4 v[224:227], v10, s[32:35], s71 offen offset:0 sc1
  buffer_load_dwordx4 v[228:231], v10, s[32:35], s71 offen offset:1024 sc1
  buffer_load_dwordx4 v[232:235], v10, s[32:35], s71 offen offset:2048 sc1
  buffer_load_dwordx4 v[236:239], v10, s[32:35], s71 offen offset:3072 sc1
  s_add_u32 s71, s74, s11
  buffer_load_dwordx4 v[240:243], v10, s[32:35], s71 offen offset:0 sc1
  buffer_load_dwordx4 v[244:247], v10, s[32:35], s71 offen offset:1024 sc1
  buffer_load_dwordx4 v[248:251], v10, s[32:35], s71 offen offset:2048 sc1
  buffer_load_dwordx4 v[252:255], v10, s[32:35], s71 offen offset:3072 sc1
  s_waitcnt vmcnt(15)
  v_mfma_f32_16x16x32_bf16 v[32:35], v[96:99], v[192:195], v[32:35]
  s_waitcnt vmcnt(14)
  v_mfma_f32_16x16x32_bf16 v[36:39], v[96:99], v[196:199], v[36:39]
  s_waitcnt vmcnt(13)
  v_mfma_f32_16x16x32_bf16 v[40:43], v[96:99], v[200:203], v[40:43]
  s_waitcnt vmcnt(12)
  v_mfma_f32_16x16x32_bf16 v[44:47], v[96:99], v[204:207], v[44:47]
  v_mfma_f32_16x16x32_bf16 v[48:51], v[100:103], v[192:195], v[48:51]
  v_mfma_f32_16x16x32_bf16 v[52:55], v[100:103], v[196:199], v[52:55]
  v_mfma_f32_16x16x32_bf16 v[56:59], v[100:103], v[200:203], v[56:59]
  v_mfma_f32_16x16x32_bf16 v[60:63], v[100:103], v[204:207], v[60:63]
  v_mfma_f32_16x16x32_bf16 v[64:67], v[104:107], v[192:195], v[64:67]
  v_mfma_f32_16x16x32_bf16 v[68:71], v[104:107], v[196:199], v[68:71]
  v_mfma_f32_16x16x32_bf16 v[72:75], v[104:107], v[200:203], v[72:75]
  v_mfma_f32_16x16x32_bf16 v[76:79], v[104:107], v[204:207], v[76:79]
  v_mfma_f32_16x16x32_bf16 v[80:83], v[108:111], v[192:195], v[80:83]
  v_mfma_f32_16x16x32_bf16 v[84:87], v[108:111], v[196:199], v[84:87]
  v_mfma_f32_16x16x32_bf16 v[88:91], v[108:111], v[200:203], v[88:91]
  v_mfma_f32_16x16x32_bf16 v[92:95], v[108:111], v[204:207], v[92:95]
  s_waitcnt vmcnt(11)
  v_mfma_f32_16x16x32_bf16 v[32:35], v[112:115], v[208:211], v[32:35]
  s_waitcnt vmcnt(10)
  v_mfma_f32_16x16x32_bf16 v[36:39], v[112:115], v[212:215], v[36:39]
  s_add_u32 s71, s74, s12
  buffer_load_dwordx4 v[96:99], v10, s[32:35], s71 offen offset:0 sc1
  s_waitcnt vmcnt(10)
  v_mfma_f32_16x16x32_bf16 v[40:43], v[112:115], v[216:219], v[40:43]
  s_waitcnt vmcnt(9)
  v_mfma_f32_16x16x32_bf16 v[44:47], v[112:115], v[220:223], v[44:47]
  buffer_load_dwordx4 v[100:103], v10, s[32:35], s71 offen offset:1024 sc1
  v_mfma_f32_16x16x32_bf16 v[48:51], v[116:119], v[208:211], v[48:51]
  v_mfma_f32_16x16x32_bf16 v[52:55], v[116:119], v[212:215], v[52:55]
  buffer_load_dwordx4 v[104:107], v10, s[32:35], s71 offen offset:2048 sc1
  v_mfma_f32_16x16x32_bf16 v[56:59], v[116:119], v[216:219], v[56:59]
  v_mfma_f32_16x16x32_bf16 v[60:63], v[116:119], v[220:223], v[60:63]
  buffer_load_dwordx4 v[108:111], v10, s[32:35], s71 offen offset:3072 sc1
  v_mfma_f32_16x16x32_bf16 v[64:67], v[120:123], v[208:211], v[64:67]
  v_mfma_f32_16x16x32_bf16 v[68:71], v[120:123], v[212:215], v[68:71]
  s_add_u32 s71, s74, s13
  buffer_load_dwordx4 v[192:195], v10, s[32:35], s71 offen offset:0 sc1
  v_mfma_f32_16x16x32_bf16 v[72:75], v[120:123], v[216:219], v[72:75]
  v_mfma_f32_16x16x32_bf16 v[76:79], v[120:123], v[220:223], v[76:79]
  buffer_load_dwordx4 v[196:199], v10, s[32:35], s71 offen offset:1024 sc1
  v_mfma_f32_16x16x32_bf16 v[80:83], v[124:127], v[208:211], v[80:83]
  v_mfma_f32_16x16x32_bf16 v[84:87], v[124:127], v[212:215], v[84:87]
  buffer_load_dwordx4 v[200:203], v10, s[32:35], s71 offen offset:2048 sc1
  v_mfma_f32_16x16x32_bf16 v[88:91], v[124:127], v[216:219], v[88:91]
  v_mfma_f32_16x16x32_bf16 v[92:95], v[124:127], v[220:223], v[92:95]
  buffer_load_dwordx4 v[204:207], v10, s[32:35], s71 offen offset:3072 sc1
  buffer_load_dword v20, v9, s[32:35], s6 offen sc1
  s_waitcnt vmcnt(16)
  v_mfma_f32_16x16x32_bf16 v[32:35], v[128:131], v[224:227], v[32:35]
  s_waitcnt vmcnt(15)
  v_mfma_f32_16x16x32_bf16 v[36:39], v[128:131], v[228:231], v[36:39]
  s_add_u32 s70, s22, s14
  buffer_load_dwordx4 v[112:115], v10, s[32:35], s70 offen offset:0 sc1
  s_waitcnt vmcnt(15)
  v_mfma_f32_16x16x32_bf16 v[40:43], v[128:131], v[232:235], v[40:43]
  s_waitcnt vmcnt(14)
  v_mfma_f32_16x16x32_bf16 v[44:47], v[128:131], v[236:239], v[44:47]
  buffer_load_dwordx4 v[116:119], v10, s[32:35], s70 offen offset:1024 sc1
  v_mfma_f32_16x16x32_bf16 v[48:51], v[132:135], v[224:227], v[48:51]
  v_mfma_f32_16x16x32_bf16 v[52:55], v[132:135], v[228:231], v[52:55]
  buffer_load_dwordx4 v[120:123], v10, s[32:35], s70 offen offset:2048 sc1
  v_mfma_f32_16x16x32_bf16 v[56:59], v[132:135], v[232:235], v[56:59]
  v_mfma_f32_16x16x32_bf16 v[60:63], v[132:135], v[236:239], v[60:63]
  buffer_load_dwordx4 v[124:127], v10, s[32:35], s70 offen offset:3072 sc1
  v_mfma_f32_16x16x32_bf16 v[64:67], v[136:139], v[224:227], v[64:67]
  v_mfma_f32_16x16x32_bf16 v[68:71], v[136:139], v[228:231], v[68:71]
  s_add_u32 s71, s74, s14
  buffer_load_dwordx4 v[208:211], v10, s[32:35], s71 offen offset:0 sc1
  v_mfma_f32_16x16x32_bf16 v[72:75], v[136:139], v[232:235], v[72:75]
  v_mfma_f32_16x16x32_bf16 v[76:79], v[136:139], v[236:239], v[76:79]
  buffer_load_dwordx4 v[212:215], v10, s[32:35], s71 offen offset:1024 sc1
  v_mfma_f32_16x16x32_bf16 v[80:83], v[140:143], v[224:227], v[80:83]
  v_mfma_f32_16x16x32_bf16 v[84:87], v[140:143], v[228:231], v[84:87]
  buffer_load_dwordx4 v[216:219], v10, s[32:35], s71 offen offset:2048 sc1
  v_mfma_f32_16x16x32_bf16 v[88:91], v[140:143], v[232:235], v[88:91]
  v_mfma_f32_16x16x32_bf16 v[92:95], v[140:143], v[236:239], v[92:95]
  buffer_load_dwordx4 v[220:223], v10, s[32:35], s71 offen offset:3072 sc1
  s_waitcnt vmcnt(20)
  v_mfma_f32_16x16x32_bf16 v[32:35], v[144:147], v[240:243], v[32:35]
  s_waitcnt vmcnt(19)
  v_mfma_f32_16x16x32_bf16 v[36:39], v[144:147], v[244:247], v[36:39]
  s_add_u32 s70, s22, s8
  s_add_u32 s70, s70, 114688
  buffer_load_dwordx4 v[128:131], v10, s[32:35], s70 offen offset:0 sc1
  s_waitcnt vmcnt(19)
  v_mfma_f32_16x16x32_bf16 v[40:43], v[144:147], v[248:251], v[40:43]
  s_waitcnt vmcnt(18)
  v_mfma_f32_16x16x32_bf16 v[44:47], v[144:147], v[252:255], v[44:47]
  buffer_load_dwordx4 v[132:135], v10, s[32:35], s70 offen offset:1024 sc1
  v_mfma_f32_16x16x32_bf16 v[48:51], v[148:151], v[240:243], v[48:51]
  v_mfma_f32_16x16x32_bf16 v[52:55], v[148:151], v[244:247], v[52:55]
  buffer_load_dwordx4 v[136:139], v10, s[32:35], s70 offen offset:2048 sc1
  v_mfma_f32_16x16x32_bf16 v[56:59], v[148:151], v[248:251], v[56:59]
  v_mfma_f32_16x16x32_bf16 v[60:63], v[148:151], v[252:255], v[60:63]
  buffer_load_dwordx4 v[140:143], v10, s[32:35], s70 offen offset:3072 sc1
  v_mfma_f32_16x16x32_bf16 v[64:67], v[152:155], v[240:243], v[64:67]
  v_mfma_f32_16x16x32_bf16 v[68:71], v[152:155], v[244:247], v[68:71]
  s_waitcnt vmcnt(12)
  v_cmp_ne_u32 vcc, v20, v13
  s_cbranch_vccnz Lfslow_169
Lfok_168:
  v_mfma_f32_16x16x32_bf16 v[72:75], v[152:155], v[248:251], v[72:75]
  v_mfma_f32_16x16x32_bf16 v[76:79], v[152:155], v[252:255], v[76:79]
  s_add_u32 s71, s74, s8
  s_add_u32 s71, s71, 114688
  buffer_load_dwordx4 v[224:227], v10, s[32:35], s71 offen offset:0 sc1
  v_mfma_f32_16x16x32_bf16 v[80:83], v[156:159], v[240:243], v[80:83]
  v_mfma_f32_16x16x32_bf16 v[84:87], v[156:159], v[244:247], v[84:87]
  buffer_load_dwordx4 v[228:231], v10, s[32:35], s71 offen offset:1024 sc1
  v_mfma_f32_16x16x32_bf16 v[88:91], v[156:159], v[248:251], v[88:91]
  v_mfma_f32_16x16x32_bf16 v[92:95], v[156:159], v[252:255], v[92:95]
  buffer_load_dwordx4 v[232:235], v10, s[32:35], s71 offen offset:2048 sc1
  buffer_load_dwordx4 v[236:239], v10, s[32:35], s71 offen offset:3072 sc1
  v_mfma_f32_16x16x32_bf16 v[32:35], v[160:163], v[96:99], v[32:35]
  v_mfma_f32_16x16x32_bf16 v[36:39], v[160:163], v[100:103], v[36:39]
  s_add_u32 s70, s22, s9
  s_add_u32 s70, s70, 114688
  buffer_load_dwordx4 v[144:147], v10, s[32:35], s70 offen offset:0 sc1
  v_mfma_f32_16x16x32_bf16 v[40:43], v[160:163], v[104:107], v[40:43]
  v_mfma_f32_16x16x32_bf16 v[44:47], v[160:163], v[108:111], v[44:47]
  buffer_load_dwordx4 v[148:151], v10, s[32:35], s70 offen offset:1024 sc1
  v_mfma_f32_16x16x32_bf16 v[48:51], v[164:167], v[96:99], v[48:51]
  v_mfma_f32_16x16x32_bf16 v[52:55], v[164:167], v[100:103], v[52:55]
  buffer_load_dwordx4 v[152:155], v10, s[32:35], s70 offen offset:2048 sc1
  v_mfma_f32_16x16x32_bf16 v[56:59], v[164:167], v[104:107], v[56:59]
  v_mfma_f32_16x16x32_bf16 v[60:63], v[164:167], v[108:111], v[60:63]
  buffer_load_dwordx4 v[156:159], v10, s[32:35], s70 offen offset:3072 sc1
  v_mfma_f32_16x16x32_bf16 v[64:67], v[168:171], v[96:99], v[64:67]
  v_mfma_f32_16x16x32_bf16 v[68:71], v[168:171], v[100:103], v[68:71]
  s_add_u32 s71, s74, s9
  s_add_u32 s71, s71, 114688
  buffer_load_dwordx4 v[240:243], v10, s[32:35], s71 offen offset:0 sc1
  v_mfma_f32_16x16x32_bf16 v[72:75], v[168:171], v[104:107], v[72:75]
  v_mfma_f32_16x16x32_bf16 v[76:79], v[168:171], v[108:111], v[76:79]
  buffer_load_dwordx4 v[244:247], v10, s[32:35], s71 offen offset:1024 sc1
  v_mfma_f32_16x16x32_bf16 v[80:83], v[172:175], v[96:99], v[80:83]
  v_mfma_f32_16x16x32_bf16 v[84:87], v[172:175], v[100:103], v[84:87]
  buffer_load_dwordx4 v[248:251], v10, s[32:35], s71 offen offset:2048 sc1
  v_mfma_f32_16x16x32_bf16 v[88:91], v[172:175], v[104:107], v[88:91]
  v_mfma_f32_16x16x32_bf16 v[92:95], v[172:175], v[108:111], v[92:95]
  buffer_load_dwordx4 v[252:255], v10, s[32:35], s71 offen offset:3072 sc1
  v_mfma_f32_16x16x32_bf16 v[32:35], v[176:179], v[192:195], v[32:35]
  v_mfma_f32_16x16x32_bf16 v[36:39], v[176:179], v[196:199], v[36:39]
  s_add_u32 s70, s22, s10
  s_add_u32 s70, s70, 114688
  buffer_load_dwordx4 v[160:163], v10, s[32:35], s70 offen offset:0 sc1
  v_mfma_f32_16x16x32_bf16 v[40:43], v[176:179], v[200:203], v[40:43]
  v_mfma_f32_16x16x32_bf16 v[44:47], v[176:179], v[204:207], v[44:47]
  buffer_load_dwordx4 v[164:167], v10, s[32:35], s70 offen offset:1024 sc1
  v_mfma_f32_16x16x32_bf16 v[48:51], v[180:183], v[192:195], v[48:51]
  v_mfma_f32_16x16x32_bf16 v[52:55], v[180:183], v[196:199], v[52:55]
  buffer_load_dwordx4 v[168:171], v10, s[32:35], s70 offen offset:2048 sc1
  v_mfma_f32_16x16x32_bf16 v[56:59], v[180:183], v[200:203], v[56:59]
  v_mfma_f32_16x16x32_bf16 v[60:63], v[180:183], v[204:207], v[60:63]
  buffer_load_dwordx4 v[172:175], v10, s[32:35], s70 offen offset:3072 sc1
  v_mfma_f32_16x16x32_bf16 v[64:67], v[184:187], v[192:195], v[64:67]
  v_mfma_f32_16x16x32_bf16 v[68:71], v[184:187], v[196:199], v[68:71]
  s_add_u32 s71, s74, s10
  s_add_u32 s71, s71, 114688
  buffer_load_dwordx4 v[96:99], v10, s[32:35], s71 offen offset:0 sc1
  v_mfma_f32_16x16x32_bf16 v[72:75], v[184:187], v[200:203], v[72:75]
  v_mfma_f32_16x16x32_bf16 v[76:79], v[184:187], v[204:207], v[76:79]
  buffer_load_dwordx4 v[100:103], v10, s[32:35], s71 offen offset:1024 sc1
  v_mfma_f32_16x16x32_bf16 v[80:83], v[188:191], v[192:195], v[80:83]
  v_mfma_f32_16x16x32_bf16 v[84:87], v[188:191], v[196:199], v[84:87]
  buffer_load_dwordx4 v[104:107], v10, s[32:35], s71 offen offset:2048 sc1
  v_mfma_f32_16x16x32_bf16 v[88:91], v[188:191], v[200:203], v[88:91]
  v_mfma_f32_16x16x32_bf16 v[92:95], v[188:191], v[204:207], v[92:95]
  buffer_load_dwordx4 v[108:111], v10, s[32:35], s71 offen offset:3072 sc1
  s_waitcnt vmcnt(27)
  v_mfma_f32_16x16x32_bf16 v[32:35], v[112:115], v[208:211], v[32:35]
  s_waitcnt vmcnt(26)
  v_mfma_f32_16x16x32_bf16 v[36:39], v[112:115], v[212:215], v[36:39]
  s_add_u32 s70, s22, s11
  s_add_u32 s70, s70, 114688
  buffer_load_dwordx4 v[176:179], v10, s[32:35], s70 offen offset:0 sc1
  s_waitcnt vmcnt(26)
  v_mfma_f32_16x16x32_bf16 v[40:43], v[112:115], v[216:219], v[40:43]
  s_waitcnt vmcnt(25)
  v_mfma_f32_16x16x32_bf16 v[44:47], v[112:115], v[220:223], v[44:47]
  buffer_load_dwordx4 v[180:183], v10, s[32:35], s70 offen offset:1024 sc1
  v_mfma_f32_16x16x32_bf16 v[48:51], v[116:119], v[208:211], v[48:51]
  v_mfma_f32_16x16x32_bf16 v[52:55], v[116:119], v[212:215], v[52:55]
  buffer_load_dwordx4 v[184:187], v10, s[32:35], s70 offen offset:2048 sc1
  v_mfma_f32_16x16x32_bf16 v[56:59], v[116:119], v[216:219], v[56:59]
  v_mfma_f32_16x16x32_bf16 v[60:63], v[116:119], v[220:223], v[60:63]
  buffer_load_dwordx4 v[188:191], v10, s[32:35], s70 offen offset:3072 sc1
  v_mfma_f32_16x16x32_bf16 v[64:67], v[120:123], v[208:211], v[64:67]
  v_mfma_f32_16x16x32_bf16 v[68:71], v[120:123], v[212:215], v[68:71]
  s_add_u32 s71, s74, s11
  s_add_u32 s71, s71, 114688
  buffer_load_dwordx4 v[192:195], v10, s[32:35], s71 offen offset:0 sc1
  v_mfma_f32_16x16x32_bf16 v[72:75], v[120:123], v[216:219], v[72:75]
  v_mfma_f32_16x16x32_bf16 v[76:79], v[120:123], v[220:223], v[76:79]
  buffer_load_dwordx4 v[196:199], v10, s[32:35], s71 offen offset:1024 sc1
  v_mfma_f32_16x16x32_bf16 v[80:83], v[124:127], v[208:211], v[80:83]
  v_mfma_f32_16x16x32_bf16 v[84:87], v[124:127], v[212:215], v[84:87]
  buffer_load_dwordx4 v[200:203], v10, s[32:35], s71 offen offset:2048 sc1
  v_mfma_f32_16x16x32_bf16 v[88:91], v[124:127], v[216:219], v[88:91]
  v_mfma_f32_16x16x32_bf16 v[92:95], v[124:127], v[220:223], v[92:95]
  buffer_load_dwordx4 v[204:207], v10, s[32:35], s71 offen offset:3072 sc1
  s_waitcnt vmcnt(27)
  v_mfma_f32_16x16x32_bf16 v[32:35], v[128:131], v[224:227], v[32:35]
  s_waitcnt vmcnt(26)
  v_mfma_f32_16x16x32_bf16 v[36:39], v[128:131], v[228:231], v[36:39]
  s_add_u32 s70, s22, s12
  s_add_u32 s70, s70, 114688
  buffer_load_dwordx4 v[112:115], v10, s[32:35], s70 offen offset:0 sc1
  s_waitcnt vmcnt(26)
  v_mfma_f32_16x16x32_bf16 v[40:43], v[128:131], v[232:235], v[40:43]
  s_waitcnt vmcnt(25)
  v_mfma_f32_16x16x32_bf16 v[44:47], v[128:131], v[236:239], v[44:47]
  buffer_load_dwordx4 v[116:119], v10, s[32:35], s70 offen offset:1024 sc1
  v_mfma_f32_16x16x32_bf16 v[48:51], v[132:135], v[224:227], v[48:51]
  v_mfma_f32_16x16x32_bf16 v[52:55], v[132:135], v[228:231], v[52:55]
  buffer_load_dwordx4 v[120:123], v10, s[32:35], s70 offen offset:2048 sc1
  v_mfma_f32_16x16x32_bf16 v[56:59], v[132:135], v[232:235], v[56:59]
  v_mfma_f32_16x16x32_bf16 v[60:63], v[132:135], v[236:239], v[60:63]
  buffer_load_dwordx4 v[124:127], v10, s[32:35], s70 offen offset:3072 sc1
  v_mfma_f32_16x16x32_bf16 v[64:67], v[136:139], v[224:227], v[64:67]
  v_mfma_f32_16x16x32_bf16 v[68:71], v[136:139], v[228:231], v[68:71]
  s_add_u32 s71, s74, s12
  s_add_u32 s71, s71, 114688
  buffer_load_dwordx4 v[208:211], v10, s[32:35], s71 offen offset:0 sc1
  v_mfma_f32_16x16x32_bf16 v[72:75], v[136:139], v[232:235], v[72:75]
  v_mfma_f32_16x16x32_bf16 v[76:79], v[136:139], v[236:239], v[76:79]
  buffer_load_dwordx4 v[212:215], v10, s[32:35], s71 offen offset:1024 sc1
  v_mfma_f32_16x16x32_bf16 v[80:83], v[140:143], v[224:227], v[80:83]
  v_mfma_f32_16x16x32_bf16 v[84:87], v[140:143], v[228:231], v[84:87]
  buffer_load_dwordx4 v[216:219], v10, s[32:35], s71 offen offset:2048 sc1
  v_mfma_f32_16x16x32_bf16 v[88:91], v[140:143], v[232:235], v[88:91]
  v_mfma_f32_16x16x32_bf16 v[92:95], v[140:143], v[236:239], v[92:95]
  buffer_load_dwordx4 v[220:223], v10, s[32:35], s71 offen offset:3072 sc1
  s_waitcnt vmcnt(27)
  v_mfma_f32_16x16x32_bf16 v[32:35], v[144:147], v[240:243], v[32:35]
  s_waitcnt vmcnt(26)
  v_mfma_f32_16x16x32_bf16 v[36:39], v[144:147], v[244:247], v[36:39]
  s_add_u32 s70, s22, s13
  s_add_u32 s70, s70, 114688
  buffer_load_dwordx4 v[128:131], v10, s[32:35], s70 offen offset:0 sc1
  s_waitcnt vmcnt(26)
  v_mfma_f32_16x16x32_bf16 v[40:43], v[144:147], v[248:251], v[40:43]
  s_waitcnt vmcnt(25)
  v_mfma_f32_16x16x32_bf16 v[44:47], v[144:147], v[252:255], v[44:47]
  buffer_load_dwordx4 v[132:135], v10, s[32:35], s70 offen offset:1024 sc1
  v_mfma_f32_16x16x32_bf16 v[48:51], v[148:151], v[240:243], v[48:51]
  v_mfma_f32_16x16x32_bf16 v[52:55], v[148:151], v[244:247], v[52:55]
  buffer_load_dwordx4 v[136:139], v10, s[32:35], s70 offen offset:2048 sc1
  v_mfma_f32_16x16x32_bf16 v[56:59], v[148:151], v[248:251], v[56:59]
  v_mfma_f32_16x16x32_bf16 v[60:63], v[148:151], v[252:255], v[60:63]
  buffer_load_dwordx4 v[140:143], v10, s[32:35], s70 offen offset:3072 sc1
  v_mfma_f32_16x16x32_bf16 v[64:67], v[152:155], v[240:243], v[64:67]
  v_mfma_f32_16x16x32_bf16 v[68:71], v[152:155], v[244:247], v[68:71]
  s_add_u32 s71, s74, s13
  s_add_u32 s71, s71, 114688
  buffer_load_dwordx4 v[224:227], v10, s[32:35], s71 offen offset:0 sc1
  v_mfma_f32_16x16x32_bf16 v[72:75], v[152:155], v[248:251], v[72:75]
  v_mfma_f32_16x16x32_bf16 v[76:79], v[152:155], v[252:255], v[76:79]
  buffer_load_dwordx4 v[228:231], v10, s[32:35], s71 offen offset:1024 sc1
  v_mfma_f32_16x16x32_bf16 v[80:83], v[156:159], v[240:243], v[80:83]
  v_mfma_f32_16x16x32_bf16 v[84:87], v[156:159], v[244:247], v[84:87]
  buffer_load_dwordx4 v[232:235], v10, s[32:35], s71 offen offset:2048 sc1
  v_mfma_f32_16x16x32_bf16 v[88:91], v[156:159], v[248:251], v[88:91]
  v_mfma_f32_16x16x32_bf16 v[92:95], v[156:159], v[252:255], v[92:95]
  buffer_load_dwordx4 v[236:239], v10, s[32:35], s71 offen offset:3072 sc1
  s_waitcnt vmcnt(27)
  v_mfma_f32_16x16x32_bf16 v[32:35], v[160:163], v[96:99], v[32:35]
  s_waitcnt vmcnt(26)
  v_mfma_f32_16x16x32_bf16 v[36:39], v[160:163], v[100:103], v[36:39]
  s_add_u32 s70, s22, s14
  s_add_u32 s70, s70, 114688
  buffer_load_dwordx4 v[144:147], v10, s[32:35], s70 offen offset:0 sc1
  s_waitcnt vmcnt(26)
  v_mfma_f32_16x16x32_bf16 v[40:43], v[160:163], v[104:107], v[40:43]
  s_waitcnt vmcnt(25)
  v_mfma_f32_16x16x32_bf16 v[44:47], v[160:163], v[108:111], v[44:47]
  buffer_load_dwordx4 v[148:151], v10, s[32:35], s70 offen offset:1024 sc1
  v_mfma_f32_16x16x32_bf16 v[48:51], v[164:167], v[96:99], v[48:51]
  v_mfma_f32_16x16x32_bf16 v[52:55], v[164:167], v[100:103], v[52:55]
  buffer_load_dwordx4 v[152:155], v10, s[32:35], s70 offen offset:2048 sc1
  v_mfma_f32_16x16x32_bf16 v[56:59], v[164:167], v[104:107], v[56:59]
  v_mfma_f32_16x16x32_bf16 v[60:63], v[164:167], v[108:111], v[60:63]
  buffer_load_dwordx4 v[156:159], v10, s[32:35], s70 offen offset:3072 sc1
  v_mfma_f32_16x16x32_bf16 v[64:67], v[168:171], v[96:99], v[64:67]
  v_mfma_f32_16x16x32_bf16 v[68:71], v[168:171], v[100:103], v[68:71]
  s_add_u32 s71, s74, s14
  s_add_u32 s71, s71, 114688
  buffer_load_dwordx4 v[240:243], v10, s[32:35], s71 offen offset:0 sc1
  v_mfma_f32_16x16x32_bf16 v[72:75], v[168:171], v[104:107], v[72:75]
  v_mfma_f32_16x16x32_bf16 v[76:79], v[168:171], v[108:111], v[76:79]
  buffer_load_dwordx4 v[244:247], v10, s[32:35], s71 offen offset:1024 sc1
  v_mfma_f32_16x16x32_bf16 v[80:83], v[172:175], v[96:99], v[80:83]
  v_mfma_f32_16x16x32_bf16 v[84:87], v[172:175], v[100:103], v[84:87]
  buffer_load_dwordx4 v[248:251], v10, s[32:35], s71 offen offset:2048 sc1
  v_mfma_f32_16x16x32_bf16 v[88:91], v[172:175], v[104:107], v[88:91]
  v_mfma_f32_16x16x32_bf16 v[92:95], v[172:175], v[108:111], v[92:95]
  buffer_load_dwordx4 v[252:255], v10, s[32:35], s71 offen offset:3072 sc1
  buffer_load_dword v21, v9, s[32:35], s78 offen sc1
  s_waitcnt vmcnt(28)
  v_mfma_f32_16x16x32_bf16 v[32:35], v[176:179], v[192:195], v[32:35]
  s_waitcnt vmcnt(27)
  v_mfma_f32_16x16x32_bf16 v[36:39], v[176:179], v[196:199], v[36:39]
  s_add_u32 s70, s23, 0
  buffer_load_dwordx4 v[160:163], v10, s[32:35], s70 offen offset:0 sc1
  s_waitcnt vmcnt(27)
  v_mfma_f32_16x16x32_bf16 v[40:43], v[176:179], v[200:203], v[40:43]
  s_waitcnt vmcnt(26)
  v_mfma_f32_16x16x32_bf16 v[44:47], v[176:179], v[204:207], v[44:47]
  buffer_load_dwordx4 v[164:167], v10, s[32:35], s70 offen offset:1024 sc1
  v_mfma_f32_16x16x32_bf16 v[48:51], v[180:183], v[192:195], v[48:51]
  v_mfma_f32_16x16x32_bf16 v[52:55], v[180:183], v[196:199], v[52:55]
  buffer_load_dwordx4 v[168:171], v10, s[32:35], s70 offen offset:2048 sc1
  v_mfma_f32_16x16x32_bf16 v[56:59], v[180:183], v[200:203], v[56:59]
  v_mfma_f32_16x16x32_bf16 v[60:63], v[180:183], v[204:207], v[60:63]
  buffer_load_dwordx4 v[172:175], v10, s[32:35], s70 offen offset:3072 sc1
  v_mfma_f32_16x16x32_bf16 v[64:67], v[184:187], v[192:195], v[64:67]
  v_mfma_f32_16x16x32_bf16 v[68:71], v[184:187], v[196:199], v[68:71]
  s_add_u32 s70, s23, 4096
  buffer_load_dwordx4 v[96:99], v10, s[32:35], s70 offen offset:0 sc1
  v_mfma_f32_16x16x32_bf16 v[72:75], v[184:187], v[200:203], v[72:75]
  v_mfma_f32_16x16x32_bf16 v[76:79], v[184:187], v[204:207], v[76:79]
  buffer_load_dwordx4 v[100:103], v10, s[32:35], s70 offen offset:1024 sc1
  v_mfma_f32_16x16x32_bf16 v[80:83], v[188:191], v[192:195], v[80:83]
  v_mfma_f32_16x16x32_bf16 v[84:87], v[188:191], v[196:199], v[84:87]
  buffer_load_dwordx4 v[104:107], v10, s[32:35], s70 offen offset:2048 sc1
  v_mfma_f32_16x16x32_bf16 v[88:91], v[188:191], v[200:203], v[88:91]
  v_mfma_f32_16x16x32_bf16 v[92:95], v[188:191], v[204:207], v[92:95]
  buffer_load_dwordx4 v[108:111], v10, s[32:35], s70 offen offset:3072 sc1
  s_waitcnt vmcnt(28)
  v_mfma_f32_16x16x32_bf16 v[32:35], v[112:115], v[208:211], v[32:35]
  s_waitcnt vmcnt(27)
  v_mfma_f32_16x16x32_bf16 v[36:39], v[112:115], v[212:215], v[36:39]
  s_waitcnt vmcnt(8)
  v_cmp_ne_u32 vcc, v21, v13
  s_cbranch_vccnz Lfslow_171
Lfok_170:
  buffer_load_dwordx4 v[24:27], v23, s[32:35], s79 offen sc1
  v_mfma_f32_16x16x32_bf16 v[40:43], v[112:115], v[216:219], v[40:43]
  v_mfma_f32_16x16x32_bf16 v[44:47], v[112:115], v[220:223], v[44:47]
  s_add_u32 s71, s75, 0
  buffer_load_dwordx4 v[176:179], v10, s[32:35], s71 offen offset:0 sc1
  v_mfma_f32_16x16x32_bf16 v[48:51], v[116:119], v[208:211], v[48:51]
  v_mfma_f32_16x16x32_bf16 v[52:55], v[116:119], v[212:215], v[52:55]
  buffer_load_dwordx4 v[180:183], v10, s[32:35], s71 offen offset:1024 sc1
  v_mfma_f32_16x16x32_bf16 v[56:59], v[116:119], v[216:219], v[56:59]
  v_mfma_f32_16x16x32_bf16 v[60:63], v[116:119], v[220:223], v[60:63]
  buffer_load_dwordx4 v[184:187], v10, s[32:35], s71 offen offset:2048 sc1
  v_mfma_f32_16x16x32_bf16 v[64:67], v[120:123], v[208:211], v[64:67]
  v_mfma_f32_16x16x32_bf16 v[68:71], v[120:123], v[212:215], v[68:71]
  buffer_load_dwordx4 v[188:191], v10, s[32:35], s71 offen offset:3072 sc1
  v_mfma_f32_16x16x32_bf16 v[72:75], v[120:123], v[216:219], v[72:75]
  v_mfma_f32_16x16x32_bf16 v[76:79], v[120:123], v[220:223], v[76:79]
  s_add_u32 s71, s75, 4096
  buffer_load_dwordx4 v[192:195], v10, s[32:35], s71 offen offset:0 sc1
  v_mfma_f32_16x16x32_bf16 v[80:83], v[124:127], v[208:211], v[80:83]
  v_mfma_f32_16x16x32_bf16 v[84:87], v[124:127], v[212:215], v[84:87]
  buffer_load_dwordx4 v[196:199], v10, s[32:35], s71 offen offset:1024 sc1
  v_mfma_f32_16x16x32_bf16 v[88:91], v[124:127], v[216:219], v[88:91]
  v_mfma_f32_16x16x32_bf16 v[92:95], v[124:127], v[220:223], v[92:95]
  buffer_load_dwordx4 v[200:203], v10, s[32:35], s71 offen offset:2048 sc1
  buffer_load_dwordx4 v[204:207], v10, s[32:35], s71 offen offset:3072 sc1
  v_mfma_f32_16x16x32_bf16 v[32:35], v[128:131], v[224:227], v[32:35]
  v_mfma_f32_16x16x32_bf16 v[36:39], v[128:131], v[228:231], v[36:39]
  s_add_u32 s70, s23, 8192
  buffer_load_dwordx4 v[112:115], v10, s[32:35], s70 offen offset:0 sc1
  v_mfma_f32_16x16x32_bf16 v[40:43], v[128:131], v[232:235], v[40:43]
  v_mfma_f32_16x16x32_bf16 v[44:47], v[128:131], v[236:239], v[44:47]
  buffer_load_dwordx4 v[116:119], v10, s[32:35], s70 offen offset:1024 sc1
  v_mfma_f32_16x16x32_bf16 v[48:51], v[132:135], v[224:227], v[48:51]
  v_mfma_f32_16x16x32_bf16 v[52:55], v[132:135], v[228:231], v[52:55]
  buffer_load_dwordx4 v[120:123], v10, s[32:35], s70 offen offset:2048 sc1
  v_mfma_f32_16x16x32_bf16 v[56:59], v[132:135], v[232:235], v[56:59]
  v_mfma_f32_16x16x32_bf16 v[60:63], v[132:135], v[236:239], v[60:63]
  buffer_load_dwordx4 v[124:127], v10, s[32:35], s70 offen offset:3072 sc1
  v_mfma_f32_16x16x32_bf16 v[64:67], v[136:139], v[224:227], v[64:67]
  v_mfma_f32_16x16x32_bf16 v[68:71], v[136:139], v[228:231], v[68:71]
  s_add_u32 s71, s75, 8192
  buffer_load_dwordx4 v[208:211], v10, s[32:35], s71 offen offset:0 sc1
  v_mfma_f32_16x16x32_bf16 v[72:75], v[136:139], v[232:235], v[72:75]
  v_mfma_f32_16x16x32_bf16 v[76:79], v[136:139], v[236:239], v[76:79]
  buffer_load_dwordx4 v[212:215], v10, s[32:35], s71 offen offset:1024 sc1
  v_mfma_f32_16x16x32_bf16 v[80:83], v[140:143], v[224:227], v[80:83]
  v_mfma_f32_16x16x32_bf16 v[84:87], v[140:143], v[228:231], v[84:87]
  buffer_load_dwordx4 v[216:219], v10, s[32:35], s71 offen offset:2048 sc1
  v_mfma_f32_16x16x32_bf16 v[88:91], v[140:143], v[232:235], v[88:91]
  v_mfma_f32_16x16x32_bf16 v[92:95], v[140:143], v[236:239], v[92:95]
  buffer_load_dwordx4 v[220:223], v10, s[32:35], s71 offen offset:3072 sc1
  v_mfma_f32_16x16x32_bf16 v[32:35], v[144:147], v[240:243], v[32:35]
  v_mfma_f32_16x16x32_bf16 v[36:39], v[144:147], v[244:247], v[36:39]
  s_add_u32 s70, s23, 12288
  buffer_load_dwordx4 v[128:131], v10, s[32:35], s70 offen offset:0 sc1
  v_mfma_f32_16x16x32_bf16 v[40:43], v[144:147], v[248:251], v[40:43]
  v_mfma_f32_16x16x32_bf16 v[44:47], v[144:147], v[252:255], v[44:47]
  buffer_load_dwordx4 v[132:135], v10, s[32:35], s70 offen offset:1024 sc1
  v_mfma_f32_16x16x32_bf16 v[48:51], v[148:151], v[240:243], v[48:51]
  v_mfma_f32_16x16x32_bf16 v[52:55], v[148:151], v[244:247], v[52:55]
  buffer_load_dwordx4 v[136:139], v10, s[32:35], s70 offen offset:2048 sc1
  v_mfma_f32_16x16x32_bf16 v[56:59], v[148:151], v[248:251], v[56:59]
  v_mfma_f32_16x16x32_bf16 v[60:63], v[148:151], v[252:255], v[60:63]
  buffer_load_dwordx4 v[140:143], v10, s[32:35], s70 offen offset:3072 sc1
  v_mfma_f32_16x16x32_bf16 v[64:67], v[152:155], v[240:243], v[64:67]
  v_mfma_f32_16x16x32_bf16 v[68:71], v[152:155], v[244:247], v[68:71]
  s_add_u32 s71, s75, 12288
  buffer_load_dwordx4 v[224:227], v10, s[32:35], s71 offen offset:0 sc1
  v_mfma_f32_16x16x32_bf16 v[72:75], v[152:155], v[248:251], v[72:75]
  v_mfma_f32_16x16x32_bf16 v[76:79], v[152:155], v[252:255], v[76:79]
  buffer_load_dwordx4 v[228:231], v10, s[32:35], s71 offen offset:1024 sc1
  v_mfma_f32_16x16x32_bf16 v[80:83], v[156:159], v[240:243], v[80:83]
  v_mfma_f32_16x16x32_bf16 v[84:87], v[156:159], v[244:247], v[84:87]
  buffer_load_dwordx4 v[232:235], v10, s[32:35], s71 offen offset:2048 sc1
  v_mfma_f32_16x16x32_bf16 v[88:91], v[156:159], v[248:251], v[88:91]
  v_mfma_f32_16x16x32_bf16 v[92:95], v[156:159], v[252:255], v[92:95]
  buffer_load_dwordx4 v[236:239], v10, s[32:35], s71 offen offset:3072 sc1
  s_waitcnt vmcnt(24)
  s_nop 7
  v_mul_f32 v32, v32, v24
  v_mul_f32 v33, v33, v24
  v_mul_f32 v34, v34, v24
  v_mul_f32 v35, v35, v24
  v_mul_f32 v36, v36, v25
  v_mul_f32 v37, v37, v25
  v_mul_f32 v38, v38, v25
  v_mul_f32 v39, v39, v25
  v_mul_f32 v40, v40, v26
  v_mul_f32 v41, v41, v26
  v_mul_f32 v42, v42, v26
  v_mul_f32 v43, v43, v26
  v_mul_f32 v44, v44, v27
  v_mul_f32 v45, v45, v27
  v_mul_f32 v46, v46, v27
  v_mul_f32 v47, v47, v27
  v_mul_f32 v48, v48, v24
  v_mul_f32 v49, v49, v24
  v_mul_f32 v50, v50, v24
  v_mul_f32 v51, v51, v24
  v_mul_f32 v52, v52, v25
  v_mul_f32 v53, v53, v25
  v_mul_f32 v54, v54, v25
  v_mul_f32 v55, v55, v25
  v_mul_f32 v56, v56, v26
  v_mul_f32 v57, v57, v26
  v_mul_f32 v58, v58, v26
  v_mul_f32 v59, v59, v26
  v_mul_f32 v60, v60, v27
  v_mul_f32 v61, v61, v27
  v_mul_f32 v62, v62, v27
  v_mul_f32 v63, v63, v27
  v_mul_f32 v64, v64, v24
  v_mul_f32 v65, v65, v24
  v_mul_f32 v66, v66, v24
  v_mul_f32 v67, v67, v24
  v_mul_f32 v68, v68, v25
  v_mul_f32 v69, v69, v25
  v_mul_f32 v70, v70, v25
  v_mul_f32 v71, v71, v25
  v_mul_f32 v72, v72, v26
  v_mul_f32 v73, v73, v26
  v_mul_f32 v74, v74, v26
  v_mul_f32 v75, v75, v26
  v_mul_f32 v76, v76, v27
  v_mul_f32 v77, v77, v27
  v_mul_f32 v78, v78, v27
  v_mul_f32 v79, v79, v27
  v_mul_f32 v80, v80, v24
  v_mul_f32 v81, v81, v24
  v_mul_f32 v82, v82, v24
  v_mul_f32 v83, v83, v24
  v_mul_f32 v84, v84, v25
  v_mul_f32 v85, v85, v25
  v_mul_f32 v86, v86, v25
  v_mul_f32 v87, v87, v25
  v_mul_f32 v88, v88, v26
  v_mul_f32 v89, v89, v26
  v_mul_f32 v90, v90, v26
  v_mul_f32 v91, v91, v26
  v_mul_f32 v92, v92, v27
  v_mul_f32 v93, v93, v27
  v_mul_f32 v94, v94, v27
  v_mul_f32 v95, v95, v27
  s_nop 1
  s_waitcnt vmcnt(23)
  v_mfma_f32_16x16x32_bf16 v[32:35], v[160:163], v[176:179], v[32:35]
  s_waitcnt vmcnt(22)
  v_mfma_f32_16x16x32_bf16 v[36:39], v[160:163], v[180:183], v[36:39]
  s_waitcnt vmcnt(21)
  v_mfma_f32_16x16x32_bf16 v[40:43], v[160:163], v[184:187], v[40:43]
  s_waitcnt vmcnt(20)
  v_mfma_f32_16x16x32_bf16 v[44:47], v[160:163], v[188:191], v[44:47]
  v_mfma_f32_16x16x32_bf16 v[48:51], v[164:167], v[176:179], v[48:51]
  v_mfma_f32_16x16x32_bf16 v[52:55], v[164:167], v[180:183], v[52:55]
  v_mfma_f32_16x16x32_bf16 v[56:59], v[164:167], v[184:187], v[56:59]
  v_mfma_f32_16x16x32_bf16 v[60:63], v[164:167], v[188:191], v[60:63]
  v_mfma_f32_16x16x32_bf16 v[64:67], v[168:171], v[176:179], v[64:67]
  v_mfma_f32_16x16x32_bf16 v[68:71], v[168:171], v[180:183], v[68:71]
  v_mfma_f32_16x16x32_bf16 v[72:75], v[168:171], v[184:187], v[72:75]
  v_mfma_f32_16x16x32_bf16 v[76:79], v[168:171], v[188:191], v[76:79]
  v_mfma_f32_16x16x32_bf16 v[80:83], v[172:175], v[176:179], v[80:83]
  v_mfma_f32_16x16x32_bf16 v[84:87], v[172:175], v[180:183], v[84:87]
  v_mfma_f32_16x16x32_bf16 v[88:91], v[172:175], v[184:187], v[88:91]
  v_mfma_f32_16x16x32_bf16 v[92:95], v[172:175], v[188:191], v[92:95]
  s_waitcnt vmcnt(19)
  v_mfma_f32_16x16x32_bf16 v[32:35], v[96:99], v[192:195], v[32:35]
  s_waitcnt vmcnt(18)
  v_mfma_f32_16x16x32_bf16 v[36:39], v[96:99], v[196:199], v[36:39]
  s_waitcnt vmcnt(17)
  v_mfma_f32_16x16x32_bf16 v[40:43], v[96:99], v[200:203], v[40:43]
  s_waitcnt vmcnt(16)
  v_mfma_f32_16x16x32_bf16 v[44:47], v[96:99], v[204:207], v[44:47]
  v_mfma_f32_16x16x32_bf16 v[48:51], v[100:103], v[192:195], v[48:51]
  v_mfma_f32_16x16x32_bf16 v[52:55], v[100:103], v[196:199], v[52:55]
  v_mfma_f32_16x16x32_bf16 v[56:59], v[100:103], v[200:203], v[56:59]
  v_mfma_f32_16x16x32_bf16 v[60:63], v[100:103], v[204:207], v[60:63]
  v_mfma_f32_16x16x32_bf16 v[64:67], v[104:107], v[192:195], v[64:67]
  v_mfma_f32_16x16x32_bf16 v[68:71], v[104:107], v[196:199], v[68:71]
  v_mfma_f32_16x16x32_bf16 v[72:75], v[104:107], v[200:203], v[72:75]
  v_mfma_f32_16x16x32_bf16 v[76:79], v[104:107], v[204:207], v[76:79]
  v_mfma_f32_16x16x32_bf16 v[80:83], v[108:111], v[192:195], v[80:83]
  v_mfma_f32_16x16x32_bf16 v[84:87], v[108:111], v[196:199], v[84:87]
  v_mfma_f32_16x16x32_bf16 v[88:91], v[108:111], v[200:203], v[88:91]
  v_mfma_f32_16x16x32_bf16 v[92:95], v[108:111], v[204:207], v[92:95]
  v_and_b32 v16, 15, v0
  v_lshrrev_b32 v17, 4, v0
  s_lshl_b32 s60, s68, 12
  v_lshl_add_u32 v17, v17, 8, s60
  v_add_u32 v18, 0, v16
  v_and_b32 v18, 15, v18
  v_lshl_add_u32 v1, v18, 4, v17
  v_add_u32 v18, 4, v16
  v_and_b32 v18, 15, v18
  v_lshl_add_u32 v2, v18, 4, v17
  v_add_u32 v18, 8, v16
  v_and_b32 v18, 15, v18
  v_lshl_add_u32 v3, v18, 4, v17
  v_add_u32 v18, 12, v16
  v_and_b32 v18, 15, v18
  v_lshl_add_u32 v4, v18, 4, v17
  v_lshrrev_b32 v16, 2, v0
  v_and_b32 v17, 3, v0
  v_lshl_add_u32 v18, v17, 2, v16
  v_and_b32 v18, 15, v18
  v_lshlrev_b32 v18, 4, v18
  v_lshl_add_u32 v18, v17, 10, v18
  s_lshl_b32 s60, s68, 14
  v_add_u32 v5, s60, v18
  s_mov_b32 s48, s26
  s_and_b32 s49, s27, 0xffff
  s_mov_b32 s50, 1835008
  s_mov_b32 s51, 0x00020000
  s_lshl_b32 s60, s57, 6
  s_lshl_b32 s61, s68, 4
  s_add_u32 s60, s60, s61
  v_add_u32 v16, s60, v16
  v_mul_u32_u24 v16, 896, v16
  v_lshl_add_u32 v22, v17, 5, v16
  s_lshl_b32 s65, s58, 7
  s_waitcnt vmcnt(11)
  v_mfma_f32_16x16x32_bf16 v[32:35], v[112:115], v[208:211], v[32:35]
  s_waitcnt vmcnt(10)
  v_mfma_f32_16x16x32_bf16 v[36:39], v[112:115], v[212:215], v[36:39]
  s_waitcnt vmcnt(9)
  v_mfma_f32_16x16x32_bf16 v[40:43], v[112:115], v[216:219], v[40:43]
  s_waitcnt vmcnt(8)
  v_mfma_f32_16x16x32_bf16 v[44:47], v[112:115], v[220:223], v[44:47]
  v_mfma_f32_16x16x32_bf16 v[48:51], v[116:119], v[208:211], v[48:51]
  v_mfma_f32_16x16x32_bf16 v[52:55], v[116:119], v[212:215], v[52:55]
  v_mfma_f32_16x16x32_bf16 v[56:59], v[116:119], v[216:219], v[56:59]
  v_mfma_f32_16x16x32_bf16 v[60:63], v[116:119], v[220:223], v[60:63]
  v_mfma_f32_16x16x32_bf16 v[64:67], v[120:123], v[208:211], v[64:67]
  v_mfma_f32_16x16x32_bf16 v[68:71], v[120:123], v[212:215], v[68:71]
  v_mfma_f32_16x16x32_bf16 v[72:75], v[120:123], v[216:219], v[72:75]
  v_mfma_f32_16x16x32_bf16 v[76:79], v[120:123], v[220:223], v[76:79]
  v_mfma_f32_16x16x32_bf16 v[80:83], v[124:127], v[208:211], v[80:83]
  v_mfma_f32_16x16x32_bf16 v[84:87], v[124:127], v[212:215], v[84:87]
  v_mfma_f32_16x16x32_bf16 v[88:91], v[124:127], v[216:219], v[88:91]
  v_mfma_f32_16x16x32_bf16 v[92:95], v[124:127], v[220:223], v[92:95]
  ds_read_b128 v[16:19], v12
  s_waitcnt vmcnt(3)
  v_mfma_f32_16x16x32_bf16 v[32:35], v[128:131], v[224:227], v[32:35]
  s_waitcnt vmcnt(2)
  v_mfma_f32_16x16x32_bf16 v[36:39], v[128:131], v[228:231], v[36:39]
  s_waitcnt vmcnt(1)
  v_mfma_f32_16x16x32_bf16 v[40:43], v[128:131], v[232:235], v[40:43]
  s_waitcnt vmcnt(0)
  v_mfma_f32_16x16x32_bf16 v[44:47], v[128:131], v[236:239], v[44:47]
  v_mfma_f32_16x16x32_bf16 v[48:51], v[132:135], v[224:227], v[48:51]
  v_mfma_f32_16x16x32_bf16 v[52:55], v[132:135], v[228:231], v[52:55]
  v_mfma_f32_16x16x32_bf16 v[56:59], v[132:135], v[232:235], v[56:59]
  v_mfma_f32_16x16x32_bf16 v[60:63], v[132:135], v[236:239], v[60:63]
  v_mfma_f32_16x16x32_bf16 v[64:67], v[136:139], v[224:227], v[64:67]
  v_mfma_f32_16x16x32_bf16 v[68:71], v[136:139], v[228:231], v[68:71]
  v_mfma_f32_16x16x32_bf16 v[72:75], v[136:139], v[232:235], v[72:75]
  v_mfma_f32_16x16x32_bf16 v[76:79], v[136:139], v[236:239], v[76:79]
  v_mfma_f32_16x16x32_bf16 v[80:83], v[140:143], v[224:227], v[80:83]
  v_mfma_f32_16x16x32_bf16 v[84:87], v[140:143], v[228:231], v[84:87]
  v_mfma_f32_16x16x32_bf16 v[88:91], v[140:143], v[232:235], v[88:91]
  v_mfma_f32_16x16x32_bf16 v[92:95], v[140:143], v[236:239], v[92:95]
  s_waitcnt lgkmcnt(0)
  v_min3_u32 v16, v16, v17, v18
  v_min_u32 v16, v16, v19
  v_cmp_gt_u32 vcc, 18, v16
  s_cbranch_vccnz Lspin_173
Lok_172:
  s_nop 2
  ds_write_b128 v1, v[32:35] offset:0
  ds_write_b128 v2, v[48:51] offset:1024
  ds_write_b128 v3, v[64:67] offset:2048
  ds_write_b128 v4, v[80:83] offset:3072
  ds_write_b128 v1, v[36:39] offset:16384
  ds_write_b128 v2, v[52:55] offset:17408
  ds_write_b128 v3, v[68:71] offset:18432
  ds_write_b128 v4, v[84:87] offset:19456
  ds_write_b128 v1, v[40:43] offset:32768
  ds_write_b128 v2, v[56:59] offset:33792
  ds_write_b128 v3, v[72:75] offset:34816
  ds_write_b128 v4, v[88:91] offset:35840
  ds_write_b128 v1, v[44:47] offset:49152
  ds_write_b128 v2, v[60:63] offset:50176
  ds_write_b128 v3, v[76:79] offset:51200
  ds_write_b128 v4, v[92:95] offset:52224
  s_waitcnt lgkmcnt(0)
  s_barrier
  ds_read_b128 v[96:99], v5 offset:0
  ds_read_b128 v[100:103], v5 offset:4096
  ds_read_b128 v[104:107], v5 offset:8192
  ds_read_b128 v[108:111], v5 offset:12288
  ds_read_b128 v[112:115], v5 offset:256
  ds_read_b128 v[116:119], v5 offset:4352
  ds_read_b128 v[120:123], v5 offset:8448
  ds_read_b128 v[124:127], v5 offset:12544
  ds_read_b128 v[128:131], v5 offset:512
  ds_read_b128 v[132:135], v5 offset:4608
  ds_read_b128 v[136:139], v5 offset:8704
  ds_read_b128 v[140:143], v5 offset:12800
  ds_read_b128 v[144:147], v5 offset:768
  ds_read_b128 v[148:151], v5 offset:4864
  ds_read_b128 v[152:155], v5 offset:8960
  ds_read_b128 v[156:159], v5 offset:13056
  s_waitcnt lgkmcnt(12)
  v_add_f32 v96, v96, v100
  v_add_f32 v104, v104, v108
  v_add_f32 v97, v97, v101
  v_add_f32 v105, v105, v109
  v_add_f32 v98, v98, v102
  v_add_f32 v106, v106, v110
  v_add_f32 v99, v99, v103
  v_add_f32 v107, v107, v111
  v_add_f32 v96, v96, v104
  v_add_f32 v97, v97, v105
  v_add_f32 v98, v98, v106
  v_add_f32 v99, v99, v107
  v_cvt_pk_bf16_f32 v32, v96, v97
  v_cvt_pk_bf16_f32 v33, v98, v99
  s_waitcnt lgkmcnt(8)
  v_add_f32 v112, v112, v116
  v_add_f32 v120, v120, v124
  v_add_f32 v113, v113, v117
  v_add_f32 v121, v121, v125
  v_add_f32 v114, v114, v118
  v_add_f32 v122, v122, v126
  v_add_f32 v115, v115, v119
  v_add_f32 v123, v123, v127
  v_add_f32 v112, v112, v120
  v_add_f32 v113, v113, v121
  v_add_f32 v114, v114, v122
  v_add_f32 v115, v115, v123
  v_cvt_pk_bf16_f32 v34, v112, v113
  v_cvt_pk_bf16_f32 v35, v114, v115
  buffer_store_dwordx4 v[32:35], v22, s[48:51], s65 offen offset:0 nt
  s_waitcnt lgkmcnt(4)
  v_add_f32 v128, v128, v132
  v_add_f32 v136, v136, v140
  v_add_f32 v129, v129, v133
  v_add_f32 v137, v137, v141
  v_add_f32 v130, v130, v134
  v_add_f32 v138, v138, v142
  v_add_f32 v131, v131, v135
  v_add_f32 v139, v139, v143
  v_add_f32 v128, v128, v136
  v_add_f32 v129, v129, v137
  v_add_f32 v130, v130, v138
  v_add_f32 v131, v131, v139
  v_cvt_pk_bf16_f32 v36, v128, v129
  v_cvt_pk_bf16_f32 v37, v130, v131
  s_waitcnt lgkmcnt(0)
  v_add_f32 v144, v144, v148
  v_add_f32 v152, v152, v156
  v_add_f32 v145, v145, v149
  v_add_f32 v153, v153, v157
  v_add_f32 v146, v146, v150
  v_add_f32 v154, v154, v158
  v_add_f32 v147, v147, v151
  v_add_f32 v155, v155, v159
  v_add_f32 v144, v144, v152
  v_add_f32 v145, v145, v153
  v_add_f32 v146, v146, v154
  v_add_f32 v147, v147, v155
  v_cvt_pk_bf16_f32 v38, v144, v145
  v_cvt_pk_bf16_f32 v39, v146, v147
  buffer_store_dwordx4 v[36:39], v22, s[48:51], s65 offen offset:16 nt
  s_endpgm
LnoP2_159:
  s_branch Lwtd_175
Lwt_174:
  s_sleep 1
Lwtd_175:
  s_getreg_b32 s3, hwreg(HW_REG_IB_STS)
  s_bfe_u32 s4, s3, 0x20016
  s_and_b32 s3, s3, 15
  s_lshl4_add_u32 s7, s4, s3
  s_sub_u32 s3, 90, s7
  v_mov_b32 v14, s3
  ds_write_b32 v15, v14
  s_cmp_gt_u32 s7, 0
  s_cbranch_scc1 Lwt_174
  s_waitcnt vmcnt(0)
  s_getreg_b32 s3, hwreg(HW_REG_IB_STS)
  s_bfe_u32 s4, s3, 0x20016
  s_and_b32 s3, s3, 15
  s_lshl4_add_u32 s7, s4, s3
  s_sub_u32 s3, 90, s7
  v_mov_b32 v14, s3
  ds_write_b32 v15, v14
  s_cmp_lg_u32 s2, 255
  s_cbranch_scc1 Lnoep_176
  s_cmp_lg_u32 s68, 0
  s_cbranch_scc1 Lnoep_176
  v_lshrrev_b32 v1, 2, v0
  v_and_b32 v2, 3, v0
  v_lshlrev_b32 v1, 13, v1
  v_lshl_add_u32 v1, v2, 10, v1
  v_add_u32 v2, 256, v1
  v_add_u32 v3, 512, v1
  v_add_u32 v4, 768, v1
  s_mov_b32 s60, 13271040
  s_mov_b32 s66, 0
Lpoll_177:
  buffer_load_dword v5, v1, s[32:35], s60 offen sc1
  buffer_load_dword v6, v2, s[32:35], s60 offen sc1
  buffer_load_dword v7, v3, s[32:35], s60 offen sc1
  buffer_load_dword v8, v4, s[32:35], s60 offen sc1
  s_add_u32 s66, s66, 1
  s_waitcnt vmcnt(0)
  v_xor_b32 v5, v5, v13
  v_xor_b32 v6, v6, v13
  v_or_b32 v5, v5, v6
  v_xor_b32 v7, v7, v13
  v_or_b32 v5, v5, v7
  v_xor_b32 v8, v8, v13
  v_or_b32 v5, v5, v8
  v_cmp_ne_u32 vcc, 0, v5
  s_cbranch_vccz Lpdone_178
  s_cmp_gt_u32 s66, 32768
  s_cbranch_scc1 Lpdone_178
  s_sleep 8
  s_branch Lpoll_177
Lpdone_178:
  s_mov_b32 s60, 13407744
  s_mov_b64 exec, 1
  buffer_store_dword v13, v11, s[32:35], s60 offen sc1
  s_mov_b64 exec, -1
Lnoep_176:
  s_endpgm
Lspin_5:
  s_mov_b32 s66, 0
Lspin_5_l:
  ds_read_b32 v24, v12 offset:36
  s_add_u32 s66, s66, 1
  s_cmp_gt_u32 s66, 262144
  s_waitcnt lgkmcnt(0)
  s_cbranch_scc1 Lok_4
  v_cmp_gt_u32 vcc, 1, v24
  s_cbranch_vccnz Lspin_5_l
  s_branch Lok_4
Lspin_7:
  s_mov_b32 s66, 0
Lspin_7_l:
  ds_read_b128 v[24:27], v12 offset:16
  s_add_u32 s66, s66, 1
  s_cmp_gt_u32 s66, 262144
  s_waitcnt lgkmcnt(0)
  s_cbranch_scc1 Lok_6
  v_min3_u32 v24, v24, v25, v26
  v_min_u32 v24, v24, v27
  v_cmp_gt_u32 vcc, 6, v24
  s_cbranch_vccnz Lspin_7_l
  s_branch Lok_6
Lspin_9:
  s_mov_b32 s66, 0
Lspin_9_l:
  ds_read_b128 v[24:27], v12 offset:16
  s_add_u32 s66, s66, 1
  s_cmp_gt_u32 s66, 262144
  s_waitcnt lgkmcnt(0)
  s_cbranch_scc1 Lok_8
  v_min3_u32 v24, v24, v25, v26
  v_min_u32 v24, v24, v27
  v_cmp_gt_u32 vcc, 12, v24
  s_cbranch_vccnz Lspin_9_l
  s_branch Lok_8
Lspin_11:
  s_mov_b32 s66, 0
Lspin_11_l:
  ds_read_b128 v[24:27], v12 offset:16
  s_add_u32 s66, s66, 1
  s_cmp_gt_u32 s66, 262144
  s_waitcnt lgkmcnt(0)
  s_cbranch_scc1 Lok_10
  v_min3_u32 v24, v24, v25, v26
  v_min_u32 v24, v24, v27
  v_cmp_gt_u32 vcc, 22, v24
  s_cbranch_vccnz Lspin_11_l
  s_branch Lok_10
Lspin_13:
  s_mov_b32 s66, 0
Lspin_13_l:
  ds_read_b128 v[24:27], v12 offset:16
  s_add_u32 s66, s66, 1
  s_cmp_gt_u32 s66, 262144
  s_waitcnt lgkmcnt(0)
  s_cbranch_scc1 Lok_12
  v_min3_u32 v24, v24, v25, v26
  v_min_u32 v24, v24, v27
  v_cmp_gt_u32 vcc, 28, v24
  s_cbranch_vccnz Lspin_13_l
  s_branch Lok_12
Lspin_15:
  s_mov_b32 s66, 0
Lspin_15_l:
  ds_read_b128 v[24:27], v12 offset:16
  s_add_u32 s66, s66, 1
  s_cmp_gt_u32 s66, 262144
  s_waitcnt lgkmcnt(0)
  s_cbranch_scc1 Lok_14
  v_min3_u32 v24, v24, v25, v26
  v_min_u32 v24, v24, v27
  v_cmp_gt_u32 vcc, 34, v24
  s_cbranch_vccnz Lspin_15_l
  s_branch Lok_14
Lspin_17:
  s_mov_b32 s66, 0
Lspin_17_l:
  ds_read_b128 v[24:27], v12 offset:16
  s_add_u32 s66, s66, 1
  s_cmp_gt_u32 s66, 262144
  s_waitcnt lgkmcnt(0)
  s_cbranch_scc1 Lok_16
  v_min3_u32 v24, v24, v25, v26
  v_min_u32 v24, v24, v27
  v_cmp_gt_u32 vcc, 40, v24
  s_cbranch_vccnz Lspin_17_l
  s_branch Lok_16
Lspin_19:
  s_mov_b32 s66, 0
Lspin_19_l:
  ds_read_b128 v[24:27], v12 offset:16
  s_add_u32 s66, s66, 1
  s_cmp_gt_u32 s66, 262144
  s_waitcnt lgkmcnt(0)
  s_cbranch_scc1 Lok_18
  v_min3_u32 v24, v24, v25, v26
  v_min_u32 v24, v24, v27
  v_cmp_gt_u32 vcc, 46, v24
  s_cbranch_vccnz Lspin_19_l
  s_branch Lok_18
Lspin_21:
  s_mov_b32 s66, 0
Lspin_21_l:
  ds_read_b128 v[24:27], v12 offset:16
  s_add_u32 s66, s66, 1
  s_cmp_gt_u32 s66, 262144
  s_waitcnt lgkmcnt(0)
  s_cbranch_scc1 Lok_20
  v_min3_u32 v24, v24, v25, v26
  v_min_u32 v24, v24, v27
  v_cmp_gt_u32 vcc, 48, v24
  s_cbranch_vccnz Lspin_21_l
  s_branch Lok_20
Lspin_23:
  s_mov_b32 s66, 0
Lspin_23_l:
  ds_read_b128 v[24:27], v12 offset:16
  s_add_u32 s66, s66, 1
  s_cmp_gt_u32 s66, 262144
  s_waitcnt lgkmcnt(0)
  s_cbranch_scc1 Lok_22
  v_min3_u32 v24, v24, v25, v26
  v_min_u32 v24, v24, v27
  v_cmp_gt_u32 vcc, 50, v24
  s_cbranch_vccnz Lspin_23_l
  s_branch Lok_22
Lspin_25:
  s_mov_b32 s66, 0
Lspin_25_l:
  ds_read_b128 v[24:27], v12 offset:16
  s_add_u32 s66, s66, 1
  s_cmp_gt_u32 s66, 262144
  s_waitcnt lgkmcnt(0)
  s_cbranch_scc1 Lok_24
  v_min3_u32 v24, v24, v25, v26
  v_min_u32 v24, v24, v27
  v_cmp_gt_u32 vcc, 52, v24
  s_cbranch_vccnz Lspin_25_l
  s_branch Lok_24
Lspin_27:
  s_mov_b32 s66, 0
Lspin_27_l:
  ds_read_b128 v[24:27], v12 offset:16
  s_add_u32 s66, s66, 1
  s_cmp_gt_u32 s66, 262144
  s_waitcnt lgkmcnt(0)
  s_cbranch_scc1 Lok_26
  v_min3_u32 v24, v24, v25, v26
  v_min_u32 v24, v24, v27
  v_cmp_gt_u32 vcc, 54, v24
  s_cbranch_vccnz Lspin_27_l
  s_branch Lok_26
Lspin_29:
  s_mov_b32 s66, 0
Lspin_29_l:
  ds_read_b128 v[24:27], v12 offset:16
  s_add_u32 s66, s66, 1
  s_cmp_gt_u32 s66, 262144
  s_waitcnt lgkmcnt(0)
  s_cbranch_scc1 Lok_28
  v_min3_u32 v24, v24, v25, v26
  v_min_u32 v24, v24, v27
  v_cmp_gt_u32 vcc, 57, v24
  s_cbranch_vccnz Lspin_29_l
  s_branch Lok_28
Lspin_31:
  s_mov_b32 s66, 0
Lspin_31_l:
  ds_read_b128 v[24:27], v12 offset:16
  s_add_u32 s66, s66, 1
  s_cmp_gt_u32 s66, 262144
  s_waitcnt lgkmcnt(0)
  s_cbranch_scc1 Lok_30
  v_min3_u32 v24, v24, v25, v26
  v_min_u32 v24, v24, v27
  v_cmp_gt_u32 vcc, 59, v24
  s_cbranch_vccnz Lspin_31_l
  s_branch Lok_30
Lspin_33:
  s_mov_b32 s66, 0
Lspin_33_l:
  ds_read_b128 v[24:27], v12 offset:16
  s_add_u32 s66, s66, 1
  s_cmp_gt_u32 s66, 262144
  s_waitcnt lgkmcnt(0)
  s_cbranch_scc1 Lok_32
  v_min3_u32 v24, v24, v25, v26
  v_min_u32 v24, v24, v27
  v_cmp_gt_u32 vcc, 61, v24
  s_cbranch_vccnz Lspin_33_l
  s_branch Lok_32
Lspin_59:
  s_mov_b32 s66, 0
Lspin_59_l:
  ds_read_b128 v[24:27], v12 offset:16
  s_add_u32 s66, s66, 1
  s_cmp_gt_u32 s66, 262144
  s_waitcnt lgkmcnt(0)
  s_cbranch_scc1 Lok_58
  v_min3_u32 v24, v24, v25, v26
  v_min_u32 v24, v24, v27
  v_cmp_gt_u32 vcc, 4, v24
  s_cbranch_vccnz Lspin_59_l
  s_branch Lok_58
Lspin_61:
  s_mov_b32 s66, 0
Lspin_61_l:
  ds_read_b128 v[24:27], v12 offset:16
  s_add_u32 s66, s66, 1
  s_cmp_gt_u32 s66, 262144
  s_waitcnt lgkmcnt(0)
  s_cbranch_scc1 Lok_60
  v_min3_u32 v24, v24, v25, v26
  v_min_u32 v24, v24, v27
  v_cmp_gt_u32 vcc, 8, v24
  s_cbranch_vccnz Lspin_61_l
  s_branch Lok_60
Lspin_64:
  s_mov_b32 s66, 0
Lspin_64_l:
  ds_read_b128 v[24:27], v12 offset:16
  s_add_u32 s66, s66, 1
  s_cmp_gt_u32 s66, 262144
  s_waitcnt lgkmcnt(0)
  s_cbranch_scc1 Lok_63
  v_min3_u32 v24, v24, v25, v26
  v_min_u32 v24, v24, v27
  v_cmp_gt_u32 vcc, 16, v24
  s_cbranch_vccnz Lspin_64_l
  s_branch Lok_63
Lspin_66:
  s_mov_b32 s66, 0
Lspin_66_l:
  ds_read_b128 v[24:27], v12 offset:16
  s_add_u32 s66, s66, 1
  s_cmp_gt_u32 s66, 262144
  s_waitcnt lgkmcnt(0)
  s_cbranch_scc1 Lok_65
  v_min3_u32 v24, v24, v25, v26
  v_min_u32 v24, v24, v27
  v_cmp_gt_u32 vcc, 20, v24
  s_cbranch_vccnz Lspin_66_l
  s_branch Lok_65
Lspin_68:
  s_mov_b32 s66, 0
Lspin_68_l:
  ds_read_b128 v[24:27], v12 offset:16
  s_add_u32 s66, s66, 1
  s_cmp_gt_u32 s66, 262144
  s_waitcnt lgkmcnt(0)
  s_cbranch_scc1 Lok_67
  v_min3_u32 v24, v24, v25, v26
  v_min_u32 v24, v24, v27
  v_cmp_gt_u32 vcc, 24, v24
  s_cbranch_vccnz Lspin_68_l
  s_branch Lok_67
Lspin_70:
  s_mov_b32 s66, 0
Lspin_70_l:
  ds_read_b128 v[24:27], v12 offset:16
  s_add_u32 s66, s66, 1
  s_cmp_gt_u32 s66, 262144
  s_waitcnt lgkmcnt(0)
  s_cbranch_scc1 Lok_69
  v_min3_u32 v24, v24, v25, v26
  v_min_u32 v24, v24, v27
  v_cmp_gt_u32 vcc, 28, v24
  s_cbranch_vccnz Lspin_70_l
  s_branch Lok_69
Lspin_72:
  s_mov_b32 s66, 0
Lspin_72_l:
  ds_read_b128 v[24:27], v12 offset:16
  s_add_u32 s66, s66, 1
  s_cmp_gt_u32 s66, 262144
  s_waitcnt lgkmcnt(0)
  s_cbranch_scc1 Lok_71
  v_min3_u32 v24, v24, v25, v26
  v_min_u32 v24, v24, v27
  v_cmp_gt_u32 vcc, 32, v24
  s_cbranch_vccnz Lspin_72_l
  s_branch Lok_71
Lspin_74:
  s_mov_b32 s66, 0
Lspin_74_l:
  ds_read_b128 v[24:27], v12 offset:16
  s_getreg_b32 s3, hwreg(HW_REG_IB_STS)
  s_and_b32 s3, s3, 0x00c0000f
  s_or_b32 s3, s3, s7
  s_cbranch_scc1 Lspin_74_n
  s_mov_b64 exec, 1
  buffer_store_dword v28, v15, s[32:35], s6 offen sc1
  s_mov_b64 exec, -1
  s_mov_b32 s7, 1
Lspin_74_n:
  s_add_u32 s66, s66, 1
  s_cmp_gt_u32 s66, 262144
  s_waitcnt lgkmcnt(0)
  s_cbranch_scc1 Lok_73
  v_min3_u32 v24, v24, v25, v26
  v_min_u32 v24, v24, v27
  v_cmp_gt_u32 vcc, 65, v24
  s_cbranch_vccnz Lspin_74_l
  s_branch Lok_73
Lspin_76:
  s_mov_b32 s66, 0
Lspin_76_l:
  ds_read_b128 v[24:27], v12 offset:16
  s_getreg_b32 s3, hwreg(HW_REG_IB_STS)
  s_and_b32 s3, s3, 0x00c0000f
  s_or_b32 s3, s3, s7
  s_cbranch_scc1 Lspin_76_n
  s_mov_b64 exec, 1
  buffer_store_dword v28, v15, s[32:35], s6 offen sc1
  s_mov_b64 exec, -1
  s_mov_b32 s7, 1
Lspin_76_n:
  s_add_u32 s66, s66, 1
  s_cmp_gt_u32 s66, 262144
  s_waitcnt lgkmcnt(0)
  s_cbranch_scc1 Lok_75
  v_min3_u32 v24, v24, v25, v26
  v_min_u32 v24, v24, v27
  v_cmp_gt_u32 vcc, 69, v24
  s_cbranch_vccnz Lspin_76_l
  s_branch Lok_75
Lspin_78:
  s_mov_b32 s66, 0
Lspin_78_l:
  ds_read_b128 v[24:27], v12 offset:16
  s_getreg_b32 s3, hwreg(HW_REG_IB_STS)
  s_and_b32 s3, s3, 0x00c0000f
  s_or_b32 s3, s3, s7
  s_cbranch_scc1 Lspin_78_n
  s_mov_b64 exec, 1
  buffer_store_dword v28, v15, s[32:35], s6 offen sc1
  s_mov_b64 exec, -1
  s_mov_b32 s7, 1
Lspin_78_n:
  s_add_u32 s66, s66, 1
  s_cmp_gt_u32 s66, 262144
  s_waitcnt lgkmcnt(0)
  s_cbranch_scc1 Lok_77
  v_min3_u32 v24, v24, v25, v26
  v_min_u32 v24, v24, v27
  v_cmp_gt_u32 vcc, 73, v24
  s_cbranch_vccnz Lspin_78_l
  s_branch Lok_77
Lspin_80:
  s_mov_b32 s66, 0
Lspin_80_l:
  ds_read_b128 v[24:27], v12 offset:16
  s_getreg_b32 s3, hwreg(HW_REG_IB_STS)
  s_and_b32 s3, s3, 0x00c0000f
  s_or_b32 s3, s3, s7
  s_cbranch_scc1 Lspin_80_n
  s_mov_b64 exec, 1
  buffer_store_dword v28, v15, s[32:35], s6 offen sc1
  s_mov_b64 exec, -1
  s_mov_b32 s7, 1
Lspin_80_n:
  s_add_u32 s66, s66, 1
  s_cmp_gt_u32 s66, 262144
  s_waitcnt lgkmcnt(0)
  s_cbranch_scc1 Lok_79
  v_min3_u32 v24, v24, v25, v26
  v_min_u32 v24, v24, v27
  v_cmp_gt_u32 vcc, 77, v24
  s_cbranch_vccnz Lspin_80_l
  s_branch Lok_79
Lspin_82:
  s_mov_b32 s66, 0
Lspin_82_l:
  ds_read_b128 v[24:27], v12 offset:16
  s_getreg_b32 s3, hwreg(HW_REG_IB_STS)
  s_and_b32 s3, s3, 0x00c0000f
  s_or_b32 s3, s3, s7
  s_cbranch_scc1 Lspin_82_n
  s_mov_b64 exec, 1
  buffer_store_dword v28, v15, s[32:35], s6 offen sc1
  s_mov_b64 exec, -1
  s_mov_b32 s7, 1
Lspin_82_n:
  s_add_u32 s66, s66, 1
  s_cmp_gt_u32 s66, 262144
  s_waitcnt lgkmcnt(0)
  s_cbranch_scc1 Lok_81
  v_min3_u32 v24, v24, v25, v26
  v_min_u32 v24, v24, v27
  v_cmp_gt_u32 vcc, 81, v24
  s_cbranch_vccnz Lspin_82_l
  s_branch Lok_81
Lspin_84:
  s_mov_b32 s66, 0
Lspin_84_l:
  ds_read_b128 v[24:27], v12 offset:16
  s_getreg_b32 s3, hwreg(HW_REG_IB_STS)
  s_and_b32 s3, s3, 0x00c0000f
  s_or_b32 s3, s3, s7
  s_cbranch_scc1 Lspin_84_n
  s_mov_b64 exec, 1
  buffer_store_dword v28, v15, s[32:35], s6 offen sc1
  s_mov_b64 exec, -1
  s_mov_b32 s7, 1
Lspin_84_n:
  s_add_u32 s66, s66, 1
  s_cmp_gt_u32 s66, 262144
  s_waitcnt lgkmcnt(0)
  s_cbranch_scc1 Lok_83
  v_min3_u32 v24, v24, v25, v26
  v_min_u32 v24, v24, v27
  v_cmp_gt_u32 vcc, 86, v24
  s_cbranch_vccnz Lspin_84_l
  s_branch Lok_83
Lspin_86:
  s_mov_b32 s66, 0
Lspin_86_l:
  ds_read_b128 v[24:27], v12 offset:16
  s_getreg_b32 s3, hwreg(HW_REG_IB_STS)
  s_and_b32 s3, s3, 0x00c0000f
  s_or_b32 s3, s3, s7
  s_cbranch_scc1 Lspin_86_n
  s_mov_b64 exec, 1
  buffer_store_dword v28, v15, s[32:35], s6 offen sc1
  s_mov_b64 exec, -1
  s_mov_b32 s7, 1
Lspin_86_n:
  s_add_u32 s66, s66, 1
  s_cmp_gt_u32 s66, 262144
  s_waitcnt lgkmcnt(0)
  s_cbranch_scc1 Lok_85
  v_min3_u32 v24, v24, v25, v26
  v_min_u32 v24, v24, v27
  v_cmp_gt_u32 vcc, 90, v24
  s_cbranch_vccnz Lspin_86_l
  s_branch Lok_85
Lspin_96:
  s_mov_b32 s66, 0
Lspin_96_l:
  ds_read_b128 v[24:27], v12 offset:0
  s_add_u32 s66, s66, 1
  s_cmp_gt_u32 s66, 262144
  s_waitcnt lgkmcnt(0)
  s_cbranch_scc1 Lok_95
  v_min3_u32 v24, v24, v25, v26
  v_min_u32 v24, v24, v27
  v_cmp_gt_u32 vcc, 16, v24
  s_cbranch_vccnz Lspin_96_l
  s_branch Lok_95
Lspin_99:
  s_mov_b32 s66, 0
Lspin_99_l:
  ds_read_b128 v[24:27], v12 offset:0
  s_add_u32 s66, s66, 1
  s_cmp_gt_u32 s66, 262144
  s_waitcnt lgkmcnt(0)
  s_cbranch_scc1 Lok_98
  v_min3_u32 v24, v24, v25, v26
  v_min_u32 v24, v24, v27
  v_cmp_gt_u32 vcc, 17, v24
  s_cbranch_vccnz Lspin_99_l
  s_branch Lok_98
Lwpf_104:
  s_mov_b32 s66, 0
  s_branch Lwpf_104_e
Lwp_102:
  s_sleep 1
Lwpf_104_e:
  ds_read_b128 v[16:19], v12
  s_getreg_b32 s3, hwreg(HW_REG_IB_STS)
  s_bfe_u32 s4, s3, 0x20016
  s_and_b32 s3, s3, 15
  s_lshl4_add_u32 s7, s4, s3
  s_sub_u32 s3, 28, s7
  v_mov_b32 v14, s3
  ds_write_b32 v15, v14
  s_add_u32 s66, s66, 1
  s_cmp_gt_u32 s66, 262144
  s_waitcnt lgkmcnt(1)
  s_cbranch_scc1 Lwpd_103
  v_min3_u32 v16, v16, v17, v18
  v_min_u32 v16, v16, v19
  s_nop 0
  v_readfirstlane_b32 s25, v16
  s_nop 0
  s_cmp_lt_u32 s25, 2
  s_cbranch_scc1 Lwp_102
  s_branch Lwpd_103
Lwpf_107:
  s_mov_b32 s66, 0
  s_branch Lwpf_107_e
Lwp_105:
  s_sleep 1
Lwpf_107_e:
  ds_read_b128 v[16:19], v12
  s_getreg_b32 s3, hwreg(HW_REG_IB_STS)
  s_bfe_u32 s4, s3, 0x20016
  s_and_b32 s3, s3, 15
  s_lshl4_add_u32 s7, s4, s3
  s_sub_u32 s3, 34, s7
  v_mov_b32 v14, s3
  ds_write_b32 v15, v14
  s_add_u32 s66, s66, 1
  s_cmp_gt_u32 s66, 262144
  s_waitcnt lgkmcnt(1)
  s_cbranch_scc1 Lwpd_106
  v_min3_u32 v16, v16, v17, v18
  v_min_u32 v16, v16, v19
  s_nop 0
  v_readfirstlane_b32 s25, v16
  s_nop 0
  s_cmp_lt_u32 s25, 3
  s_cbranch_scc1 Lwp_105
  s_branch Lwpd_106
Lwpf_110:
  s_mov_b32 s66, 0
  s_branch Lwpf_110_e
Lwp_108:
  s_sleep 1
Lwpf_110_e:
  ds_read_b128 v[16:19], v12
  s_getreg_b32 s3, hwreg(HW_REG_IB_STS)
  s_bfe_u32 s4, s3, 0x20016
  s_and_b32 s3, s3, 15
  s_lshl4_add_u32 s7, s4, s3
  s_sub_u32 s3, 40, s7
  v_mov_b32 v14, s3
  ds_write_b32 v15, v14
  s_add_u32 s66, s66, 1
  s_cmp_gt_u32 s66, 262144
  s_waitcnt lgkmcnt(1)
  s_cbranch_scc1 Lwpd_109
  v_min3_u32 v16, v16, v17, v18
  v_min_u32 v16, v16, v19
  s_nop 0
  v_readfirstlane_b32 s25, v16
  s_nop 0
  s_cmp_lt_u32 s25, 4
  s_cbranch_scc1 Lwp_108
  s_branch Lwpd_109
Lwpf_113:
  s_mov_b32 s66, 0
  s_branch Lwpf_113_e
Lwp_111:
  s_sleep 1
Lwpf_113_e:
  ds_read_b128 v[16:19], v12
  s_getreg_b32 s3, hwreg(HW_REG_IB_STS)
  s_bfe_u32 s4, s3, 0x20016
  s_and_b32 s3, s3, 15
  s_lshl4_add_u32 s7, s4, s3
  s_sub_u32 s3, 52, s7
  v_mov_b32 v14, s3
  ds_write_b32 v15, v14
  s_add_u32 s66, s66, 1
  s_cmp_gt_u32 s66, 262144
  s_waitcnt lgkmcnt(1)
  s_cbranch_scc1 Lwpd_112
  v_min3_u32 v16, v16, v17, v18
  v_min_u32 v16, v16, v19
  s_nop 0
  v_readfirstlane_b32 s25, v16
  s_nop 0
  s_cmp_lt_u32 s25, 5
  s_cbranch_scc1 Lwp_111
  s_branch Lwpd_112
Lwpf_116:
  s_mov_b32 s66, 0
  s_branch Lwpf_116_e
Lwp_114:
  s_sleep 1
Lwpf_116_e:
  ds_read_b128 v[16:19], v12
  s_getreg_b32 s3, hwreg(HW_REG_IB_STS)
  s_bfe_u32 s4, s3, 0x20016
  s_and_b32 s3, s3, 15
  s_lshl4_add_u32 s7, s4, s3
  s_sub_u32 s3, 57, s7
  v_mov_b32 v14, s3
  ds_write_b32 v15, v14
  s_add_u32 s66, s66, 1
  s_cmp_gt_u32 s66, 262144
  s_waitcnt lgkmcnt(1)
  s_cbranch_scc1 Lwpd_115
  v_min3_u32 v16, v16, v17, v18
  v_min_u32 v16, v16, v19
  s_nop 0
  v_readfirstlane_b32 s25, v16
  s_nop 0
  s_cmp_lt_u32 s25, 6
  s_cbranch_scc1 Lwp_114
  s_branch Lwpd_115
Lwpf_119:
  s_mov_b32 s66, 0
  s_branch Lwpf_119_e
Lwp_117:
  s_sleep 1
Lwpf_119_e:
  ds_read_b128 v[16:19], v12
  s_getreg_b32 s3, hwreg(HW_REG_IB_STS)
  s_bfe_u32 s4, s3, 0x20016
  s_and_b32 s3, s3, 15
  s_lshl4_add_u32 s7, s4, s3
  s_sub_u32 s3, 20, s7
  v_mov_b32 v14, s3
  ds_write_b32 v15, v14
  s_add_u32 s66, s66, 1
  s_cmp_gt_u32 s66, 262144
  s_waitcnt lgkmcnt(1)
  s_cbranch_scc1 Lwpd_118
  v_min3_u32 v16, v16, v17, v18
  v_min_u32 v16, v16, v19
  s_nop 0
  v_readfirstlane_b32 s25, v16
  s_nop 0
  s_cmp_lt_u32 s25, 2
  s_cbranch_scc1 Lwp_117
  s_branch Lwpd_118
Lwpf_122:
  s_mov_b32 s66, 0
  s_branch Lwpf_122_e
Lwp_120:
  s_sleep 1
Lwpf_122_e:
  ds_read_b128 v[16:19], v12
  s_getreg_b32 s3, hwreg(HW_REG_IB_STS)
  s_bfe_u32 s4, s3, 0x20016
  s_and_b32 s3, s3, 15
  s_lshl4_add_u32 s7, s4, s3
  s_sub_u32 s3, 24, s7
  v_mov_b32 v14, s3
  ds_write_b32 v15, v14
  s_add_u32 s66, s66, 1
  s_cmp_gt_u32 s66, 262144
  s_waitcnt lgkmcnt(1)
  s_cbranch_scc1 Lwpd_121
  v_min3_u32 v16, v16, v17, v18
  v_min_u32 v16, v16, v19
  s_nop 0
  v_readfirstlane_b32 s25, v16
  s_nop 0
  s_cmp_lt_u32 s25, 3
  s_cbranch_scc1 Lwp_120
  s_branch Lwpd_121
Lwpf_125:
  s_mov_b32 s66, 0
  s_branch Lwpf_125_e
Lwp_123:
  s_sleep 1
Lwpf_125_e:
  ds_read_b128 v[16:19], v12
  s_getreg_b32 s3, hwreg(HW_REG_IB_STS)
  s_bfe_u32 s4, s3, 0x20016
  s_and_b32 s3, s3, 15
  s_lshl4_add_u32 s7, s4, s3
  s_sub_u32 s3, 28, s7
  v_mov_b32 v14, s3
  ds_write_b32 v15, v14
  s_add_u32 s66, s66, 1
  s_cmp_gt_u32 s66, 262144
  s_waitcnt lgkmcnt(1)
  s_cbranch_scc1 Lwpd_124
  v_min3_u32 v16, v16, v17, v18
  v_min_u32 v16, v16, v19
  s_nop 0
  v_readfirstlane_b32 s25, v16
  s_nop 0
  s_cmp_lt_u32 s25, 4
  s_cbranch_scc1 Lwp_123
  s_branch Lwpd_124
Lgslow_131:
  s_mov_b32 s66, 0
Lgslow_131_l:
  buffer_load_dword v20, v22, s[32:35], s20 offen sc1
Lgslow_131_w:
  s_getreg_b32 s3, hwreg(HW_REG_IB_STS)
  s_bfe_u32 s4, s3, 0x20016
  s_and_b32 s3, s3, 15
  s_lshl4_add_u32 s7, s4, s3
  s_sub_u32 s3, 62, s7
  s_min_u32 s3, s3, 61
  v_mov_b32 v14, s3
  ds_write_b32 v15, v14
  s_cmp_lg_u32 s7, 0
  s_cbranch_scc1 Lgslow_131_w
  s_add_u32 s66, s66, 1
  s_cmp_gt_u32 s66, 32768
  s_waitcnt vmcnt(0)
  s_cbranch_scc1 Lgok_130
  v_cmp_ne_u32 vcc, v20, v13
  s_cbranch_vccz Lgok_130
  s_sleep 1
  s_branch Lgslow_131_l
Lwpf_134:
  s_mov_b32 s66, 0
  s_branch Lwpf_134_e
Lwp_132:
  s_sleep 1
Lwpf_134_e:
  ds_read_b128 v[16:19], v12
  s_getreg_b32 s3, hwreg(HW_REG_IB_STS)
  s_bfe_u32 s4, s3, 0x20016
  s_and_b32 s3, s3, 15
  s_lshl4_add_u32 s7, s4, s3
  s_sub_u32 s3, 61, s7
  v_mov_b32 v14, s3
  ds_write_b32 v15, v14
  s_add_u32 s66, s66, 1
  s_cmp_gt_u32 s66, 262144
  s_waitcnt lgkmcnt(1)
  s_cbranch_scc1 Lwpd_133
  v_min3_u32 v16, v16, v17, v18
  v_min_u32 v16, v16, v19
  s_nop 0
  v_readfirstlane_b32 s25, v16
  s_nop 0
  s_cmp_lt_u32 s25, 3
  s_cbranch_scc1 Lwp_132
  s_branch Lwpd_133
Lwpf_137:
  s_mov_b32 s66, 0
  s_branch Lwpf_137_e
Lwp_135:
  s_sleep 1
Lwpf_137_e:
  ds_read_b128 v[16:19], v12
  s_getreg_b32 s3, hwreg(HW_REG_IB_STS)
  s_bfe_u32 s4, s3, 0x20016
  s_and_b32 s3, s3, 15
  s_lshl4_add_u32 s7, s4, s3
  s_sub_u32 s3, 63, s7
  v_mov_b32 v14, s3
  ds_write_b32 v15, v14
  s_add_u32 s66, s66, 1
  s_cmp_gt_u32 s66, 262144
  s_waitcnt lgkmcnt(1)
  s_cbranch_scc1 Lwpd_136
  v_min3_u32 v16, v16, v17, v18
  v_min_u32 v16, v16, v19
  s_nop 0
  v_readfirstlane_b32 s25, v16
  s_nop 0
  s_cmp_lt_u32 s25, 4
  s_cbranch_scc1 Lwp_135
  s_branch Lwpd_136
Lwpf_140:
  s_mov_b32 s66, 0
  s_branch Lwpf_140_e
Lwp_138:
  s_sleep 1
Lwpf_140_e:
  ds_read_b128 v[16:19], v12
  s_getreg_b32 s3, hwreg(HW_REG_IB_STS)
  s_bfe_u32 s4, s3, 0x20016
  s_and_b32 s3, s3, 15
  s_lshl4_add_u32 s7, s4, s3
  s_sub_u32 s3, 65, s7
  v_mov_b32 v14, s3
  ds_write_b32 v15, v14
  s_add_u32 s66, s66, 1
  s_cmp_gt_u32 s66, 262144
  s_waitcnt lgkmcnt(1)
  s_cbranch_scc1 Lwpd_139
  v_min3_u32 v16, v16, v17, v18
  v_min_u32 v16, v16, v19
  s_nop 0
  v_readfirstlane_b32 s25, v16
  s_nop 0
  s_cmp_lt_u32 s25, 5
  s_cbranch_scc1 Lwp_138
  s_branch Lwpd_139
Lwpf_143:
  s_mov_b32 s66, 0
  s_branch Lwpf_143_e
Lwp_141:
  s_sleep 1
Lwpf_143_e:
  ds_read_b128 v[16:19], v12
  s_getreg_b32 s3, hwreg(HW_REG_IB_STS)
  s_bfe_u32 s4, s3, 0x20016
  s_and_b32 s3, s3, 15
  s_lshl4_add_u32 s7, s4, s3
  s_sub_u32 s3, 67, s7
  v_mov_b32 v14, s3
  ds_write_b32 v15, v14
  s_add_u32 s66, s66, 1
  s_cmp_gt_u32 s66, 262144
  s_waitcnt lgkmcnt(1)
  s_cbranch_scc1 Lwpd_142
  v_min3_u32 v16, v16, v17, v18
  v_min_u32 v16, v16, v19
  s_nop 0
  v_readfirstlane_b32 s25, v16
  s_nop 0
  s_cmp_lt_u32 s25, 6
  s_cbranch_scc1 Lwp_141
  s_branch Lwpd_142
Lwpf_146:
  s_mov_b32 s66, 0
  s_branch Lwpf_146_e
Lwp_144:
  s_sleep 1
Lwpf_146_e:
  ds_read_b128 v[16:19], v12
  s_getreg_b32 s3, hwreg(HW_REG_IB_STS)
  s_bfe_u32 s4, s3, 0x20016
  s_and_b32 s3, s3, 15
  s_lshl4_add_u32 s7, s4, s3
  s_sub_u32 s3, 69, s7
  v_mov_b32 v14, s3
  ds_write_b32 v15, v14
  s_add_u32 s66, s66, 1
  s_cmp_gt_u32 s66, 262144
  s_waitcnt lgkmcnt(1)
  s_cbranch_scc1 Lwpd_145
  v_min3_u32 v16, v16, v17, v18
  v_min_u32 v16, v16, v19
  s_nop 0
  v_readfirstlane_b32 s25, v16
  s_nop 0
  s_cmp_lt_u32 s25, 7
  s_cbranch_scc1 Lwp_144
  s_branch Lwpd_145
Lwpf_149:
  s_mov_b32 s66, 0
  s_branch Lwpf_149_e
Lwp_147:
  s_sleep 1
Lwpf_149_e:
  ds_read_b128 v[16:19], v12
  s_getreg_b32 s3, hwreg(HW_REG_IB_STS)
  s_bfe_u32 s4, s3, 0x20016
  s_and_b32 s3, s3, 15
  s_lshl4_add_u32 s7, s4, s3
  s_sub_u32 s3, 71, s7
  v_mov_b32 v14, s3
  ds_write_b32 v15, v14
  s_add_u32 s66, s66, 1
  s_cmp_gt_u32 s66, 262144
  s_waitcnt lgkmcnt(1)
  s_cbranch_scc1 Lwpd_148
  v_min3_u32 v16, v16, v17, v18
  v_min_u32 v16, v16, v19
  s_nop 0
  v_readfirstlane_b32 s25, v16
  s_nop 0
  s_cmp_lt_u32 s25, 8
  s_cbranch_scc1 Lwp_147
  s_branch Lwpd_148
Lwpf_152:
  s_mov_b32 s66, 0
  s_branch Lwpf_152_e
Lwp_150:
  s_sleep 1
Lwpf_152_e:
  ds_read_b128 v[16:19], v12
  s_getreg_b32 s3, hwreg(HW_REG_IB_STS)
  s_bfe_u32 s4, s3, 0x20016
  s_and_b32 s3, s3, 15
  s_lshl4_add_u32 s7, s4, s3
  s_sub_u32 s3, 73, s7
  v_mov_b32 v14, s3
  ds_write_b32 v15, v14
  s_add_u32 s66, s66, 1
  s_cmp_gt_u32 s66, 262144
  s_waitcnt lgkmcnt(1)
  s_cbranch_scc1 Lwpd_151
  v_min3_u32 v16, v16, v17, v18
  v_min_u32 v16, v16, v19
  s_nop 0
  v_readfirstlane_b32 s25, v16
  s_nop 0
  s_cmp_lt_u32 s25, 9
  s_cbranch_scc1 Lwp_150
  s_branch Lwpd_151
Lwpf_155:
  s_mov_b32 s66, 0
  s_branch Lwpf_155_e
Lwp_153:
  s_sleep 1
Lwpf_155_e:
  ds_read_b128 v[16:19], v12
  s_getreg_b32 s3, hwreg(HW_REG_IB_STS)
  s_bfe_u32 s4, s3, 0x20016
  s_and_b32 s3, s3, 15
  s_lshl4_add_u32 s7, s4, s3
  s_sub_u32 s3, 86, s7
  v_mov_b32 v14, s3
  ds_write_b32 v15, v14
  s_add_u32 s66, s66, 1
  s_cmp_gt_u32 s66, 262144
  s_waitcnt lgkmcnt(1)
  s_cbranch_scc1 Lwpd_154
  v_min3_u32 v16, v16, v17, v18
  v_min_u32 v16, v16, v19
  s_nop 0
  v_readfirstlane_b32 s25, v16
  s_nop 0
  s_cmp_lt_u32 s25, 10
  s_cbranch_scc1 Lwp_153
  s_branch Lwpd_154
Lwpf_158:
  s_mov_b32 s66, 0
  s_branch Lwpf_158_e
Lwp_156:
  s_sleep 1
Lwpf_158_e:
  ds_read_b128 v[16:19], v12
  s_getreg_b32 s3, hwreg(HW_REG_IB_STS)
  s_bfe_u32 s4, s3, 0x20016
  s_and_b32 s3, s3, 15
  s_lshl4_add_u32 s7, s4, s3
  s_sub_u32 s3, 88, s7
  v_mov_b32 v14, s3
  ds_write_b32 v15, v14
  s_add_u32 s66, s66, 1
  s_cmp_gt_u32 s66, 262144
  s_waitcnt lgkmcnt(1)
  s_cbranch_scc1 Lwpd_157
  v_min3_u32 v16, v16, v17, v18
  v_min_u32 v16, v16, v19
  s_nop 0
  v_readfirstlane_b32 s25, v16
  s_nop 0
  s_cmp_lt_u32 s25, 11
  s_cbranch_scc1 Lwp_156
  s_branch Lwpd_157
Lgslow_163:
  s_mov_b32 s66, 0
Lgslow_163_l:
  buffer_load_dword v21, v23, s[32:35], s21 offen sc1
Lgslow_163_w:
  s_getreg_b32 s3, hwreg(HW_REG_IB_STS)
  s_bfe_u32 s4, s3, 0x20016
  s_and_b32 s3, s3, 15
  s_lshl4_add_u32 s7, s4, s3
  s_sub_u32 s3, 91, s7
  s_min_u32 s3, s3, 90
  v_mov_b32 v14, s3
  ds_write_b32 v15, v14
  s_cmp_lg_u32 s7, 0
  s_cbranch_scc1 Lgslow_163_w
  s_add_u32 s66, s66, 1
  s_cmp_gt_u32 s66, 32768
  s_waitcnt vmcnt(0)
  s_cbranch_scc1 Lgok_162
  v_cmp_ne_u32 vcc, v21, v13
  s_cbranch_vccz Lgok_162
  s_sleep 1
  s_branch Lgslow_163_l
Lgslow_167:
  s_mov_b32 s66, 0
Lgslow_167_l:
  buffer_load_dword v20, v9, s[32:35], s77 offen sc1
Lgslow_167_w:
  s_getreg_b32 s3, hwreg(HW_REG_IB_STS)
  s_bfe_u32 s4, s3, 0x20016
  s_and_b32 s3, s3, 15
  s_lshl4_add_u32 s7, s4, s3
  s_sub_u32 s3, 116, s7
  s_min_u32 s3, s3, 115
  v_mov_b32 v14, s3
  ds_write_b32 v15, v14
  s_cmp_lg_u32 s7, 0
  s_cbranch_scc1 Lgslow_167_w
  s_add_u32 s66, s66, 1
  s_cmp_gt_u32 s66, 32768
  s_waitcnt vmcnt(0)
  s_cbranch_scc1 Lgok_166
  v_cmp_ne_u32 vcc, v20, v13
  s_cbranch_vccz Lgok_166
  s_sleep 1
  s_branch Lgslow_167_l
Lfslow_169:
  s_mov_b32 s66, 0
Lfslow_169_l:
  buffer_load_dword v20, v9, s[32:35], s6 offen sc1
  s_add_u32 s66, s66, 1
  s_cmp_gt_u32 s66, 32768
  s_waitcnt vmcnt(0)
  s_cbranch_scc1 Lfok_168
  v_cmp_ne_u32 vcc, v20, v13
  s_cbranch_vccz Lfok_168
  s_branch Lfslow_169_l
Lfslow_171:
  s_mov_b32 s66, 0
Lfslow_171_l:
  buffer_load_dword v21, v9, s[32:35], s78 offen sc1
  s_add_u32 s66, s66, 1
  s_cmp_gt_u32 s66, 32768
  s_waitcnt vmcnt(0)
  s_cbranch_scc1 Lfok_170
  v_cmp_ne_u32 vcc, v21, v13
  s_cbranch_vccz Lfok_170
  s_branch Lfslow_171_l
Lspin_173:
  s_mov_b32 s66, 0
Lspin_173_l:
  ds_read_b128 v[16:19], v12 offset:0
  s_add_u32 s66, s66, 1
  s_cmp_gt_u32 s66, 262144
  s_waitcnt lgkmcnt(0)
  s_cbranch_scc1 Lok_172
  v_min3_u32 v16, v16, v17, v18
  v_min_u32 v16, v16, v19
  v_cmp_gt_u32 vcc, 18, v16
  s_cbranch_vccnz Lspin_173_l
  s_branch Lok_172
L_exit:
  s_endpgm
.section .rodata,"a"
.p2align 6
.amdhsa_kernel gated_mix__sliding_local_dilated__dense_activation_squared_relu__prompt_kernel
  .amdhsa_next_free_vgpr 256
  .amdhsa_next_free_sgpr 102
  .amdhsa_accum_offset 256
  .amdhsa_group_segment_fixed_size 0
  .amdhsa_kernarg_size 96
  .amdhsa_user_sgpr_count 2
  .amdhsa_user_sgpr_kernarg_segment_ptr 1
  .amdhsa_system_sgpr_workgroup_id_x 1
  .amdhsa_float_denorm_mode_32 3
.end_amdhsa_kernel
```
